```python
import torch

def _softmax(x, axis=-1):
    return torch.softmax(x, dim=axis)
def _gelu(x):
    return torch.nn.functional.gelu(x, approximate="tanh")
def _silu(x):
    return torch.nn.functional.silu(x)
def _sigmoid(x):
    return torch.sigmoid(x)
def _layernorm(x, axis=-1, eps=1e-5):
    m = x.mean(dim=axis, keepdim=True)
    v = x.var(dim=axis, keepdim=True, unbiased=False)
    return (x - m) / torch.sqrt(v + eps)
def _scatter_add(tgt, idx, src, axis=0):
    return tgt.clone().index_add_(axis, idx, src)
def _segment_sum(src, seg, n):
    out = torch.zeros((n,) + src.shape[1:], dtype=src.dtype)
    return out.index_add_(0, seg, src)
def _pad(x, pw):
    flat = tuple(v for pair in reversed(pw) for v in pair)
    return torch.nn.functional.pad(x, flat)

kernel_name = 'parallel_sum__gqa_block_cached__glu_gated_swiglu__decode'

def setup_inputs():

    _w = (lambda a: (lambda t: t.to(torch.bfloat16) if t.is_floating_point() else t)(torch.as_tensor(a)))
    def _A_setup():
        B, Sq, D = 1, 1, 640
        Hq, Hkv, Sk, Dh = 32, 32, 8192, 128
        assert Hq % Hkv == 0, (Hq, Hkv)
        return {
            "x": _w((lambda *s: torch.randn(*s, dtype=torch.bfloat16) * 0.05)(B, Sq, D)),
            "k_cache": _w((lambda *s: torch.randn(*s, dtype=torch.bfloat16) * 1.6)(B, Hkv, Sk, Dh)),
            "v_cache": _w((lambda *s: torch.randn(*s, dtype=torch.bfloat16) * 0.8)(B, Hkv, Sk, Dh)),
            "wq": _w((lambda *s: torch.randn(*s, dtype=torch.bfloat16) * 1.6)(D, Hq * Dh) * (D ** -0.5)),
            "wo": _w((lambda *s: torch.randn(*s, dtype=torch.bfloat16) * 0.8)(Hq * Dh, D) * ((Hq * Dh) ** -0.5)),
        }
    _A_in = _A_setup()

    def _B_setup():
        B, S, D, F = 1, 1, 640, 1728
        return {
            "x": _w((lambda *s: torch.randn(*s, dtype=torch.bfloat16) * 0.05)(B, S, D)),
            "w1": _w((lambda *s: torch.randn(*s, dtype=torch.bfloat16) * 0.4)(D, F) * (2.0 / D) ** 0.5),
            "w3": _w((lambda *s: torch.randn(*s, dtype=torch.bfloat16) * 0.4)(D, F) * (2.0 / D) ** 0.5),
            "w2": _w((lambda *s: torch.randn(*s, dtype=torch.bfloat16) * 0.4)(F, D) * (2.0 / F) ** 0.5),
        }
    _B_in = _B_setup()

    return {
        "A_x": _A_in["x"],
        "A_k_cache": _A_in["k_cache"],
        "A_v_cache": _A_in["v_cache"],
        "A_wq": _A_in["wq"],
        "A_wo": _A_in["wo"],
        "B_x": _B_in["x"],
        "B_w1": _B_in["w1"],
        "B_w3": _B_in["w3"],
        "B_w2": _B_in["w2"],
    }

def reference(A_x, A_k_cache, A_v_cache, A_wq, A_wo, B_x, B_w1, B_w3, B_w2):
    def _A_ref(x, k_cache, v_cache, wq, wo):
        B, Sq, D = x.shape
        Hq, Dh = 32, 128
        Hkv = k_cache.shape[1]
        rep = Hq // Hkv
        q = (lambda x, *d: x.permute(*d))((x @ wq).reshape(B, Sq, Hq, Dh), 0, 2, 1, 3)
        k = (lambda x, n, axis: torch.repeat_interleave(x, n, dim=axis))(k_cache, rep, axis=1)
        v = (lambda x, n, axis: torch.repeat_interleave(x, n, dim=axis))(v_cache, rep, axis=1)
        scores = torch.einsum("bhqd,bhkd->bhqk", q, k) * (Dh ** -0.5)
        p = _softmax(scores, axis=-1)
        o = torch.einsum("bhqk,bhkd->bhqd", p, v)
        return (lambda x, *d: x.permute(*d))(o, 0, 2, 1, 3).reshape(B, Sq, Hq * Dh) @ wo

    def _B_ref(x, w1, w3, w2):
        gate = torch.einsum("bsd,df->bsf", x, w1)
        up = torch.einsum("bsd,df->bsf", x, w3)
        h = _silu(gate) * up
        out = torch.einsum("bsf,fd->bsd", h, w2)
        return out

    x = A_x
    xn = _layernorm(x, axis=-1)
    return x + _A_ref(xn, A_k_cache, A_v_cache, A_wq, A_wo) + _B_ref(xn, B_w1, B_w3, B_w2)
```

```asm
; @launch grid=(256,1,1) block=(640,1,1) lds=12288
.amdgcn_target "amdgcn-amd-amdhsa--gfx950"
.text
.globl parallel_sum__gqa_block_cached__glu_gated_swiglu__decode_kernel
.p2align 8
.type parallel_sum__gqa_block_cached__glu_gated_swiglu__decode_kernel,@function
parallel_sum__gqa_block_cached__glu_gated_swiglu__decode_kernel:
  s_cmp_ge_u32 s2, 256
  s_cbranch_scc1 L_end
  s_load_dwordx16 s[16:31], s[0:1], 0
  s_load_dwordx8 s[32:39], s[0:1], 64
  v_lshrrev_b32 v1, 6, v0
  v_and_b32 v0, 63, v0
  s_and_b32 s4, s2, 7
  v_readfirstlane_b32 s3, v1
  s_lshr_b32 s5, s2, 3
  s_and_b32 s6, s5, 3
  s_lshl_b32 s4, s4, 2
  s_add_u32 s4, s4, s6
  s_lshr_b32 s5, s5, 2
  s_lshl_b32 s6, s4, 3
  s_add_u32 s6, s6, s5
  s_cmp_lt_u32 s3, 8
  s_cbranch_scc1 L_stream
  s_getpc_b64 s[94:95]
  s_sub_u32 s7, s3, 8
  s_lshl_b32 s7, s7, 13
  v_lshlrev_b32 v2, 7, v0
  v_add_u32 v2, s7, v2
  global_load_dword v167, v2, s[94:95]
  s_cmp_eq_u32 s3, 9
  s_cbranch_scc1 L_aux1
  s_branch L_aux0
L_stream:
  s_lshl_b32 s7, s4, 21
  s_lshl_b32 s8, s5, 18
  s_add_u32 s7, s7, s8
  s_lshl_b32 s8, s3, 10
  s_add_u32 s7, s7, s8
  v_bfe_u32 v36, v0, 2, 2
  v_lshlrev_b32 v36, 8, v36
  v_lshrrev_b32 v2, 4, v0
  v_lshlrev_b32 v2, 6, v2
  v_and_b32 v3, 3, v0
  v_lshlrev_b32 v3, 4, v3
  v_add3_u32 v36, v36, v2, v3
  v_add_u32 v36, s7, v36
  v_lshlrev_b32 v1, 4, v0
  v_add_u32 v1, s7, v1
  s_mov_b32 s42, 0x4000000
  s_mov_b32 s43, 0x20000
  s_mov_b32 s7, 0
  s_waitcnt lgkmcnt(0)
  s_mov_b32 s40, s18
  s_mov_b32 s41, s19
  buffer_load_dwordx4 v[40:43], v36, s[40:43], s7 offen nt
  s_add_u32 s7, s7, 0x2000
  buffer_load_dwordx4 v[44:47], v36, s[40:43], s7 offen nt
  s_add_u32 s7, s7, 0x2000
  buffer_load_dwordx4 v[48:51], v36, s[40:43], s7 offen nt
  s_add_u32 s7, s7, 0x2000
  s_mov_b32 s44, s20
  s_mov_b32 s45, s21
  s_mov_b32 s46, 0x4000000
  s_mov_b32 s47, 0x20000
  s_mov_b32 s48, s24
  s_mov_b32 s49, s25
  s_mov_b32 s50, 0x500000
  s_mov_b32 s51, 0x20000
  s_mov_b32 s52, s32
  s_mov_b32 s53, s33
  s_mov_b32 s54, 0x21c000
  s_mov_b32 s55, 0x20000
  s_mov_b32 s56, s38
  s_mov_b32 s57, s39
  s_mov_b32 s58, 0x400000
  s_mov_b32 s59, 0x20000
  s_barrier
  v_and_b32 v26, 1, v0
  v_lshlrev_b32 v26, 4, v26
  v_mov_b32 v27, 0xffff
  v_lshlrev_b32 v26, v26, v27
  v_bfe_u32 v27, v0, 1, 2
  v_mov_b32 v32, 1
  v_lshlrev_b32 v27, v27, v32
  v_bfe_i32 v32, v27, 0, 1
  v_bfe_i32 v33, v27, 1, 1
  v_bfe_i32 v34, v27, 2, 1
  v_bfe_i32 v35, v27, 3, 1
  v_and_b32 v32, v32, v26
  v_and_b32 v33, v33, v26
  v_and_b32 v34, v34, v26
  v_and_b32 v35, v35, v26
  s_mov_b32 s8, 0x22222222
  s_mov_b32 s9, 0x22222222
  s_mov_b32 s10, 0x44444444
  s_mov_b32 s11, 0x44444444
  s_mov_b32 s12, 0x88888888
  s_mov_b32 s13, 0x88888888
  v_lshrrev_b32 v26, 4, v0
  v_and_b32 v27, 15, v0
  s_mul_i32 s14, s5, 160
  v_lshlrev_b32 v28, 4, v27
  v_add_u32 v28, s14, v28
  v_mov_b32 v29, 0x40000000
  v_cmp_gt_u32 vcc, 10, v27
  s_nop 1
  v_cndmask_b32 v28, v29, v28, vcc
  s_lshl_b32 s14, s4, 7
  s_lshl_b32 s15, s3, 4
  s_add_u32 s14, s14, s15
  s_mul_i32 s14, s14, 1280
  v_lshrrev_b32 v29, 1, v26
  v_lshlrev_b32 v29, 3, v29
  v_and_b32 v30, 1, v26
  v_add_u32 v29, v29, v30
  v_mul_u32_u24 v29, 1280, v29
  v_add3_u32 v2, v28, v29, s14
  s_lshl_b32 s14, s4, 6
  s_lshl_b32 s15, s3, 3
  s_add_u32 s14, s14, s15
  s_mul_i32 s14, s14, 1280
  v_mul_u32_u24 v29, 2560, v26
  v_add3_u32 v3, v28, v29, s14
  v_and_b32 v29, 1, v26
  v_lshlrev_b32 v29, 4, v29
  v_lshlrev_b32 v37, 5, v27
  s_lshl_b32 s14, s3, 9
  v_add3_u32 v37, v37, v29, s14
  v_bfe_u32 v29, v0, 2, 3
  v_lshlrev_b32 v29, 10, v29
  v_lshrrev_b32 v30, 5, v0
  v_lshlrev_b32 v30, 6, v30
  v_and_b32 v31, 3, v0
  v_lshlrev_b32 v31, 4, v31
  v_add3_u32 v38, v29, v30, v31
  s_lshl_b32 s14, s4, 13
  s_lshl_b32 s15, s3, 7
  s_add_u32 s14, s14, s15
  v_add_u32 v38, s14, v38
  s_lshl_b32 s14, s3, 4
  v_lshlrev_b32 v39, 2, v26
  v_add_u32 v39, s14, v39
  s_waitcnt vmcnt(2)
  buffer_load_dwordx4 v[52:55], v36, s[40:43], s7 offen nt
  s_add_u32 s7, s7, 0x2000
  s_waitcnt vmcnt(1)
  buffer_load_dwordx4 v[56:59], v36, s[40:43], s7 offen nt
  s_add_u32 s7, s7, 0x2000
  buffer_load_dwordx4 v[60:63], v36, s[40:43], s7 offen nt
  s_add_u32 s7, s7, 0x2000
  s_waitcnt vmcnt(2)
  buffer_load_dwordx4 v[64:67], v36, s[40:43], s7 offen nt
  s_add_u32 s7, s7, 0x2000
  s_waitcnt vmcnt(2)
  buffer_load_dwordx4 v[68:71], v36, s[40:43], s7 offen nt
  s_add_u32 s7, s7, 0x2000
  s_waitcnt vmcnt(2)
  buffer_load_dwordx4 v[72:75], v36, s[40:43], s7 offen nt
  s_add_u32 s7, s7, 0x2000
  s_waitcnt vmcnt(1)
  buffer_load_dwordx4 v[76:79], v36, s[40:43], s7 offen nt
  s_add_u32 s7, s7, 0x2000
  buffer_load_dwordx4 v[80:83], v36, s[40:43], s7 offen nt
  s_add_u32 s7, s7, 0x2000
  s_waitcnt vmcnt(2)
  buffer_load_dwordx4 v[84:87], v36, s[40:43], s7 offen nt
  s_add_u32 s7, s7, 0x2000
  s_waitcnt vmcnt(2)
  buffer_load_dwordx4 v[88:91], v36, s[40:43], s7 offen nt
  s_add_u32 s7, s7, 0x2000
  s_waitcnt vmcnt(2)
  buffer_load_dwordx4 v[92:95], v36, s[40:43], s7 offen nt
  s_add_u32 s7, s7, 0x2000
  s_waitcnt vmcnt(1)
  buffer_load_dwordx4 v[96:99], v36, s[40:43], s7 offen nt
  s_add_u32 s7, s7, 0x2000
  buffer_load_dwordx4 v[100:103], v36, s[40:43], s7 offen nt
  s_add_u32 s7, s7, 0x2000
  s_waitcnt vmcnt(2)
  buffer_load_dwordx4 v[104:107], v36, s[40:43], s7 offen nt
  s_add_u32 s7, s7, 0x2000
  s_waitcnt vmcnt(2)
  buffer_load_dwordx4 v[108:111], v36, s[40:43], s7 offen nt
  s_add_u32 s7, s7, 0x2000
  s_waitcnt vmcnt(2)
  buffer_load_dwordx4 v[112:115], v36, s[40:43], s7 offen nt
  s_add_u32 s7, s7, 0x2000
  s_waitcnt vmcnt(1)
  buffer_load_dwordx4 v[116:119], v36, s[40:43], s7 offen nt
  s_add_u32 s7, s7, 0x2000
  buffer_load_dwordx4 v[120:123], v36, s[40:43], s7 offen nt
  s_add_u32 s7, s7, 0x2000
  s_waitcnt vmcnt(2)
  buffer_load_dwordx4 v[124:127], v36, s[40:43], s7 offen nt
  s_add_u32 s7, s7, 0x2000
  s_waitcnt vmcnt(2)
  buffer_load_dwordx4 v[128:131], v36, s[40:43], s7 offen nt
  s_add_u32 s7, s7, 0x2000
  s_waitcnt vmcnt(2)
  buffer_load_dwordx4 v[132:135], v36, s[40:43], s7 offen nt
  s_add_u32 s7, s7, 0x2000
  s_waitcnt vmcnt(1)
  buffer_load_dwordx4 v[136:139], v36, s[40:43], s7 offen nt
  s_add_u32 s7, s7, 0x2000
  buffer_load_dwordx4 v[140:143], v36, s[40:43], s7 offen nt
  s_add_u32 s7, s7, 0x2000
  s_waitcnt vmcnt(2)
  buffer_load_dwordx4 v[144:147], v36, s[40:43], s7 offen nt
  s_add_u32 s7, s7, 0x2000
  s_waitcnt vmcnt(2)
  buffer_load_dwordx4 v[148:151], v36, s[40:43], s7 offen nt
  s_add_u32 s7, s7, 0x2000
  v_mov_b32 v31, 0
  s_mov_b32 s14, 65536
L_sp_1:
  ds_read_b32 v30, v31 offset:2944
  s_waitcnt lgkmcnt(0)
  v_readfirstlane_b32 s15, v30
  s_nop 0
  s_cmp_lg_u32 s15, 0
  s_cbranch_scc1 L_spd_2
  s_sub_u32 s14, s14, 1
  s_cmp_lg_u32 s14, 0
  s_cbranch_scc1 L_sp_1
L_spd_2:
  v_lshrrev_b32 v30, 4, v0
  v_lshlrev_b32 v30, 6, v30
  v_and_b32 v29, 3, v0
  v_lshlrev_b32 v29, 4, v29
  v_add_u32 v30, v30, v29
  ds_read_b128 v[26:29], v30 offset:2560
  ds_read_b64 v[20:21], v31 offset:2960
  s_mov_b32 s62, 0xf000f
  s_mov_b32 s63, 0xf000f
  s_waitcnt lgkmcnt(0)
  v_cndmask_b32_e64 v4, 0, v26, s[62:63]
  v_cndmask_b32_e64 v5, 0, v27, s[62:63]
  v_cndmask_b32_e64 v6, 0, v28, s[62:63]
  v_cndmask_b32_e64 v7, 0, v29, s[62:63]
  s_mov_b32 s64, 0xf000f0
  s_mov_b32 s65, 0xf000f0
  v_cndmask_b32_e64 v8, 0, v26, s[64:65]
  v_cndmask_b32_e64 v9, 0, v27, s[64:65]
  v_cndmask_b32_e64 v10, 0, v28, s[64:65]
  v_cndmask_b32_e64 v11, 0, v29, s[64:65]
  s_mov_b32 s62, 0xf000f00
  s_mov_b32 s63, 0xf000f00
  v_cndmask_b32_e64 v12, 0, v26, s[62:63]
  v_cndmask_b32_e64 v13, 0, v27, s[62:63]
  v_cndmask_b32_e64 v14, 0, v28, s[62:63]
  v_cndmask_b32_e64 v15, 0, v29, s[62:63]
  s_mov_b32 s64, 0xf000f000
  s_mov_b32 s65, 0xf000f000
  v_cndmask_b32_e64 v16, 0, v26, s[64:65]
  v_cndmask_b32_e64 v17, 0, v27, s[64:65]
  v_cndmask_b32_e64 v18, 0, v28, s[64:65]
  v_cndmask_b32_e64 v19, 0, v29, s[64:65]
  v_readfirstlane_b32 s69, v20
  v_readfirstlane_b32 s90, v21
  v_mfma_f32_16x16x32_bf16 v[20:23], v[40:43], v[4:7], 0
  v_mfma_f32_16x16x32_bf16 v[20:23], v[44:47], v[8:11], v[20:23]
  v_mfma_f32_16x16x32_bf16 v[20:23], v[48:51], v[12:15], v[20:23]
  v_mfma_f32_16x16x32_bf16 v[20:23], v[52:55], v[16:19], v[20:23]
  v_mfma_f32_16x16x32_bf16 v[26:29], v[56:59], v[4:7], 0
  v_mfma_f32_16x16x32_bf16 v[26:29], v[60:63], v[8:11], v[26:29]
  v_mfma_f32_16x16x32_bf16 v[26:29], v[64:67], v[12:15], v[26:29]
  v_mfma_f32_16x16x32_bf16 v[26:29], v[68:71], v[16:19], v[26:29]
  s_nop 3
  v_cndmask_b32_e64 v30, v20, v21, s[8:9]
  v_cndmask_b32_e64 v30, v30, v22, s[10:11]
  v_cndmask_b32_e64 v30, v30, v23, s[12:13]
  s_nop 1
  v_add_f32_dpp v30, v30, v30 quad_perm:[1,0,3,2] row_mask:0xf bank_mask:0xf
  s_nop 1
  v_add_f32_dpp v24, v30, v30 quad_perm:[2,3,0,1] row_mask:0xf bank_mask:0xf
  s_waitcnt vmcnt(2)
  buffer_load_dwordx4 v[152:155], v36, s[40:43], s7 offen nt
  s_add_u32 s7, s7, 0x2000
  v_mfma_f32_16x16x32_bf16 v[20:23], v[72:75], v[4:7], 0
  v_mfma_f32_16x16x32_bf16 v[20:23], v[76:79], v[8:11], v[20:23]
  v_mfma_f32_16x16x32_bf16 v[20:23], v[80:83], v[12:15], v[20:23]
  v_mfma_f32_16x16x32_bf16 v[20:23], v[84:87], v[16:19], v[20:23]
  v_cndmask_b32_e64 v30, v26, v27, s[8:9]
  v_cndmask_b32_e64 v30, v30, v28, s[10:11]
  v_cndmask_b32_e64 v30, v30, v29, s[12:13]
  s_nop 1
  v_add_f32_dpp v30, v30, v30 quad_perm:[1,0,3,2] row_mask:0xf bank_mask:0xf
  s_nop 1
  v_add_f32_dpp v30, v30, v30 quad_perm:[2,3,0,1] row_mask:0xf bank_mask:0xf
  v_cndmask_b32_e64 v24, v24, v30, s[8:9]
  v_mfma_f32_16x16x32_bf16 v[26:29], v[88:91], v[4:7], 0
  v_mfma_f32_16x16x32_bf16 v[26:29], v[92:95], v[8:11], v[26:29]
  v_mfma_f32_16x16x32_bf16 v[26:29], v[96:99], v[12:15], v[26:29]
  v_mfma_f32_16x16x32_bf16 v[26:29], v[100:103], v[16:19], v[26:29]
  v_cndmask_b32_e64 v30, v20, v21, s[8:9]
  v_cndmask_b32_e64 v30, v30, v22, s[10:11]
  v_cndmask_b32_e64 v30, v30, v23, s[12:13]
  s_nop 1
  v_add_f32_dpp v30, v30, v30 quad_perm:[1,0,3,2] row_mask:0xf bank_mask:0xf
  s_nop 1
  v_add_f32_dpp v30, v30, v30 quad_perm:[2,3,0,1] row_mask:0xf bank_mask:0xf
  v_cndmask_b32_e64 v24, v24, v30, s[10:11]
  s_waitcnt vmcnt(1)
  buffer_load_dwordx4 v[156:159], v36, s[40:43], s7 offen nt
  s_add_u32 s7, s7, 0x2000
  v_mfma_f32_16x16x32_bf16 v[20:23], v[104:107], v[4:7], 0
  v_mfma_f32_16x16x32_bf16 v[20:23], v[108:111], v[8:11], v[20:23]
  v_mfma_f32_16x16x32_bf16 v[20:23], v[112:115], v[12:15], v[20:23]
  v_mfma_f32_16x16x32_bf16 v[20:23], v[116:119], v[16:19], v[20:23]
  v_cndmask_b32_e64 v30, v26, v27, s[8:9]
  v_cndmask_b32_e64 v30, v30, v28, s[10:11]
  v_cndmask_b32_e64 v30, v30, v29, s[12:13]
  s_nop 1
  v_add_f32_dpp v30, v30, v30 quad_perm:[1,0,3,2] row_mask:0xf bank_mask:0xf
  s_nop 1
  v_add_f32_dpp v30, v30, v30 quad_perm:[2,3,0,1] row_mask:0xf bank_mask:0xf
  v_cndmask_b32_e64 v24, v24, v30, s[12:13]
  v_mfma_f32_16x16x32_bf16 v[26:29], v[120:123], v[4:7], 0
  v_mfma_f32_16x16x32_bf16 v[26:29], v[124:127], v[8:11], v[26:29]
  v_mfma_f32_16x16x32_bf16 v[26:29], v[128:131], v[12:15], v[26:29]
  v_mfma_f32_16x16x32_bf16 v[26:29], v[132:135], v[16:19], v[26:29]
  v_cndmask_b32_e64 v30, v20, v21, s[8:9]
  v_cndmask_b32_e64 v30, v30, v22, s[10:11]
  v_cndmask_b32_e64 v30, v30, v23, s[12:13]
  s_nop 1
  v_add_f32_dpp v30, v30, v30 quad_perm:[1,0,3,2] row_mask:0xf bank_mask:0xf
  s_nop 1
  v_add_f32_dpp v25, v30, v30 quad_perm:[2,3,0,1] row_mask:0xf bank_mask:0xf
  buffer_load_dwordx4 v[160:163], v36, s[40:43], s7 offen nt
  s_add_u32 s7, s7, 0x2000
  v_mfma_f32_16x16x32_bf16 v[20:23], v[136:139], v[4:7], 0
  v_mfma_f32_16x16x32_bf16 v[20:23], v[140:143], v[8:11], v[20:23]
  v_mfma_f32_16x16x32_bf16 v[20:23], v[144:147], v[12:15], v[20:23]
  v_mfma_f32_16x16x32_bf16 v[20:23], v[148:151], v[16:19], v[20:23]
  v_cndmask_b32_e64 v30, v26, v27, s[8:9]
  v_cndmask_b32_e64 v30, v30, v28, s[10:11]
  v_cndmask_b32_e64 v30, v30, v29, s[12:13]
  s_nop 1
  v_add_f32_dpp v30, v30, v30 quad_perm:[1,0,3,2] row_mask:0xf bank_mask:0xf
  s_nop 1
  v_add_f32_dpp v30, v30, v30 quad_perm:[2,3,0,1] row_mask:0xf bank_mask:0xf
  v_cndmask_b32_e64 v25, v25, v30, s[8:9]
  s_waitcnt vmcnt(2)
  buffer_load_dwordx4 v[164:167], v36, s[40:43], s7 offen nt
  s_waitcnt vmcnt(2)
  s_mov_b32 s7, 0
  buffer_load_dwordx4 v[40:43], v1, s[44:47], s7 offen nt
  s_add_u32 s7, s7, 0x2000
  s_waitcnt vmcnt(2)
  buffer_load_dwordx4 v[44:47], v1, s[44:47], s7 offen nt
  s_add_u32 s7, s7, 0x2000
  s_waitcnt vmcnt(1)
  buffer_load_dwordx4 v[48:51], v1, s[44:47], s7 offen nt
  s_add_u32 s7, s7, 0x2000
  v_mfma_f32_16x16x32_bf16 v[26:29], v[152:155], v[4:7], 0
  v_mfma_f32_16x16x32_bf16 v[26:29], v[156:159], v[8:11], v[26:29]
  v_mfma_f32_16x16x32_bf16 v[26:29], v[160:163], v[12:15], v[26:29]
  v_mfma_f32_16x16x32_bf16 v[26:29], v[164:167], v[16:19], v[26:29]
  v_cndmask_b32_e64 v30, v20, v21, s[8:9]
  v_cndmask_b32_e64 v30, v30, v22, s[10:11]
  v_cndmask_b32_e64 v30, v30, v23, s[12:13]
  s_nop 1
  v_add_f32_dpp v30, v30, v30 quad_perm:[1,0,3,2] row_mask:0xf bank_mask:0xf
  s_nop 1
  v_add_f32_dpp v30, v30, v30 quad_perm:[2,3,0,1] row_mask:0xf bank_mask:0xf
  v_cndmask_b32_e64 v25, v25, v30, s[10:11]
  v_cndmask_b32_e64 v30, v26, v27, s[8:9]
  v_cndmask_b32_e64 v30, v30, v28, s[10:11]
  v_cndmask_b32_e64 v30, v30, v29, s[12:13]
  s_nop 1
  v_add_f32_dpp v30, v30, v30 quad_perm:[1,0,3,2] row_mask:0xf bank_mask:0xf
  s_nop 1
  v_add_f32_dpp v30, v30, v30 quad_perm:[2,3,0,1] row_mask:0xf bank_mask:0xf
  v_cndmask_b32_e64 v25, v25, v30, s[12:13]
  v_cvt_pk_bf16_f32 v26, v24, v25
  v_lshlrev_b32 v24, 16, v26
  v_and_b32 v25, 0xffff0000, v26
  v_mul_f32 v24, 0x3db504f3, v24
  v_mul_f32 v25, 0x3db504f3, v25
  v_cvt_pk_bf16_f32 v26, v24, v25
  v_lshlrev_b32 v24, 16, v26
  v_and_b32 v25, 0xffff0000, v26
  v_max_f32 v27, v24, v25
  s_nop 1
  v_max_f32_dpp v27, v27, v27 row_ror:8 row_mask:0xf bank_mask:0xf
  s_nop 1
  v_max_f32_dpp v27, v27, v27 row_ror:4 row_mask:0xf bank_mask:0xf
  s_nop 1
  v_max_f32_dpp v27, v27, v27 row_ror:2 row_mask:0xf bank_mask:0xf
  s_nop 1
  v_max_f32_dpp v27, v27, v27 row_ror:1 row_mask:0xf bank_mask:0xf
  s_nop 1
  v_max_f32_dpp v27, v27, v27 row_bcast:15 row_mask:0xa bank_mask:0xf
  s_nop 1
  v_max_f32_dpp v27, v27, v27 row_bcast:31 row_mask:0xc bank_mask:0xf
  s_nop 0
  v_readlane_b32 s60, v27, 63
  s_nop 1
  v_subrev_f32 v24, s60, v24
  v_subrev_f32 v25, s60, v25
  v_mul_f32 v24, 0x3fb8aa3b, v24
  v_mul_f32 v25, 0x3fb8aa3b, v25
  v_exp_f32 v24, v24
  v_exp_f32 v25, v25
  s_lshl_b32 s14, s3, 3
  v_mov_b32 v30, s14
  v_add_f32 v27, v24, v25
  v_cvt_pk_bf16_f32 v24, v24, v24
  v_cvt_pk_bf16_f32 v25, v25, v25
  v_add_f32_dpp v27, v27, v27 row_ror:8 row_mask:0xf bank_mask:0xf
  s_nop 1
  v_add_f32_dpp v27, v27, v27 row_ror:4 row_mask:0xf bank_mask:0xf
  s_nop 1
  v_add_f32_dpp v27, v27, v27 row_ror:2 row_mask:0xf bank_mask:0xf
  s_nop 1
  v_add_f32_dpp v27, v27, v27 row_ror:1 row_mask:0xf bank_mask:0xf
  s_nop 1
  v_add_f32_dpp v27, v27, v27 row_bcast:15 row_mask:0xa bank_mask:0xf
  s_nop 1
  v_add_f32_dpp v27, v27, v27 row_bcast:31 row_mask:0xc bank_mask:0xf
  s_nop 0
  v_readlane_b32 s61, v27, 63
  v_mov_b32 v28, s60
  s_lshl_b32 s14, s3, 2
  v_mov_b32 v31, s14
  v_mov_b32 v29, s61
  v_mov_b32 v27, 1
  s_mov_b64 exec, 1
  ds_write_b64 v30, v[28:29] offset:3008
  ds_write_b32 v31, v27 offset:2976
  s_mov_b64 exec, -1
  v_and_b32_dpp v12, v24, v32 row_newbcast:0 row_mask:0xf bank_mask:0xf
  v_and_b32_dpp v13, v24, v33 row_newbcast:0 row_mask:0xf bank_mask:0xf
  v_and_b32_dpp v14, v24, v34 row_newbcast:0 row_mask:0xf bank_mask:0xf
  v_and_b32_dpp v15, v24, v35 row_newbcast:0 row_mask:0xf bank_mask:0xf
  buffer_load_dwordx4 v[52:55], v1, s[44:47], s7 offen nt
  s_add_u32 s7, s7, 0x2000
  v_mfma_f32_16x16x32_bf16 v[20:23], v[12:15], v[40:43], 0
  v_and_b32_dpp v16, v24, v32 row_newbcast:4 row_mask:0xf bank_mask:0xf
  v_and_b32_dpp v17, v24, v33 row_newbcast:4 row_mask:0xf bank_mask:0xf
  v_and_b32_dpp v18, v24, v34 row_newbcast:4 row_mask:0xf bank_mask:0xf
  v_and_b32_dpp v19, v24, v35 row_newbcast:4 row_mask:0xf bank_mask:0xf
  s_waitcnt vmcnt(2)
  buffer_load_dwordx4 v[56:59], v1, s[44:47], s7 offen nt
  s_add_u32 s7, s7, 0x2000
  v_mfma_f32_16x16x32_bf16 v[20:23], v[16:19], v[44:47], v[20:23]
  v_and_b32_dpp v12, v24, v32 row_newbcast:8 row_mask:0xf bank_mask:0xf
  v_and_b32_dpp v13, v24, v33 row_newbcast:8 row_mask:0xf bank_mask:0xf
  v_and_b32_dpp v14, v24, v34 row_newbcast:8 row_mask:0xf bank_mask:0xf
  v_and_b32_dpp v15, v24, v35 row_newbcast:8 row_mask:0xf bank_mask:0xf
  s_waitcnt vmcnt(2)
  buffer_load_dwordx4 v[60:63], v1, s[44:47], s7 offen nt
  s_add_u32 s7, s7, 0x2000
  v_mfma_f32_16x16x32_bf16 v[20:23], v[12:15], v[48:51], v[20:23]
  v_and_b32_dpp v16, v24, v32 row_newbcast:12 row_mask:0xf bank_mask:0xf
  v_and_b32_dpp v17, v24, v33 row_newbcast:12 row_mask:0xf bank_mask:0xf
  v_and_b32_dpp v18, v24, v34 row_newbcast:12 row_mask:0xf bank_mask:0xf
  v_and_b32_dpp v19, v24, v35 row_newbcast:12 row_mask:0xf bank_mask:0xf
  s_waitcnt vmcnt(2)
  buffer_load_dwordx4 v[64:67], v1, s[44:47], s7 offen nt
  s_add_u32 s7, s7, 0x2000
  v_mfma_f32_16x16x32_bf16 v[20:23], v[16:19], v[52:55], v[20:23]
  v_and_b32_dpp v12, v24, v32 row_newbcast:1 row_mask:0xf bank_mask:0xf
  v_and_b32_dpp v13, v24, v33 row_newbcast:1 row_mask:0xf bank_mask:0xf
  v_and_b32_dpp v14, v24, v34 row_newbcast:1 row_mask:0xf bank_mask:0xf
  v_and_b32_dpp v15, v24, v35 row_newbcast:1 row_mask:0xf bank_mask:0xf
  s_waitcnt vmcnt(1)
  buffer_load_dwordx4 v[68:71], v1, s[44:47], s7 offen nt
  s_add_u32 s7, s7, 0x2000
  v_mfma_f32_16x16x32_bf16 v[20:23], v[12:15], v[56:59], v[20:23]
  v_and_b32_dpp v16, v24, v32 row_newbcast:5 row_mask:0xf bank_mask:0xf
  v_and_b32_dpp v17, v24, v33 row_newbcast:5 row_mask:0xf bank_mask:0xf
  v_and_b32_dpp v18, v24, v34 row_newbcast:5 row_mask:0xf bank_mask:0xf
  v_and_b32_dpp v19, v24, v35 row_newbcast:5 row_mask:0xf bank_mask:0xf
  s_nop 1
  v_mfma_f32_16x16x32_bf16 v[20:23], v[16:19], v[60:63], v[20:23]
  v_and_b32_dpp v12, v24, v32 row_newbcast:9 row_mask:0xf bank_mask:0xf
  v_and_b32_dpp v13, v24, v33 row_newbcast:9 row_mask:0xf bank_mask:0xf
  v_and_b32_dpp v14, v24, v34 row_newbcast:9 row_mask:0xf bank_mask:0xf
  v_and_b32_dpp v15, v24, v35 row_newbcast:9 row_mask:0xf bank_mask:0xf
  buffer_load_dwordx4 v[72:75], v1, s[44:47], s7 offen nt
  s_add_u32 s7, s7, 0x2000
  s_waitcnt vmcnt(2)
  buffer_load_dwordx4 v[76:79], v1, s[44:47], s7 offen nt
  s_add_u32 s7, s7, 0x2000
  v_mfma_f32_16x16x32_bf16 v[20:23], v[12:15], v[64:67], v[20:23]
  v_and_b32_dpp v16, v24, v32 row_newbcast:13 row_mask:0xf bank_mask:0xf
  v_and_b32_dpp v17, v24, v33 row_newbcast:13 row_mask:0xf bank_mask:0xf
  v_and_b32_dpp v18, v24, v34 row_newbcast:13 row_mask:0xf bank_mask:0xf
  v_and_b32_dpp v19, v24, v35 row_newbcast:13 row_mask:0xf bank_mask:0xf
  s_waitcnt vmcnt(2)
  buffer_load_dwordx4 v[80:83], v1, s[44:47], s7 offen nt
  s_add_u32 s7, s7, 0x2000
  v_mfma_f32_16x16x32_bf16 v[20:23], v[16:19], v[68:71], v[20:23]
  v_and_b32_dpp v12, v24, v32 row_newbcast:2 row_mask:0xf bank_mask:0xf
  v_and_b32_dpp v13, v24, v33 row_newbcast:2 row_mask:0xf bank_mask:0xf
  v_and_b32_dpp v14, v24, v34 row_newbcast:2 row_mask:0xf bank_mask:0xf
  v_and_b32_dpp v15, v24, v35 row_newbcast:2 row_mask:0xf bank_mask:0xf
  s_waitcnt vmcnt(2)
  buffer_load_dwordx4 v[84:87], v1, s[44:47], s7 offen nt
  s_add_u32 s7, s7, 0x2000
  v_mfma_f32_16x16x32_bf16 v[20:23], v[12:15], v[72:75], v[20:23]
  v_and_b32_dpp v16, v24, v32 row_newbcast:6 row_mask:0xf bank_mask:0xf
  v_and_b32_dpp v17, v24, v33 row_newbcast:6 row_mask:0xf bank_mask:0xf
  v_and_b32_dpp v18, v24, v34 row_newbcast:6 row_mask:0xf bank_mask:0xf
  v_and_b32_dpp v19, v24, v35 row_newbcast:6 row_mask:0xf bank_mask:0xf
  s_waitcnt vmcnt(1)
  buffer_load_dwordx4 v[88:91], v1, s[44:47], s7 offen nt
  s_add_u32 s7, s7, 0x2000
  v_mfma_f32_16x16x32_bf16 v[20:23], v[16:19], v[76:79], v[20:23]
  v_and_b32_dpp v12, v24, v32 row_newbcast:10 row_mask:0xf bank_mask:0xf
  v_and_b32_dpp v13, v24, v33 row_newbcast:10 row_mask:0xf bank_mask:0xf
  v_and_b32_dpp v14, v24, v34 row_newbcast:10 row_mask:0xf bank_mask:0xf
  v_and_b32_dpp v15, v24, v35 row_newbcast:10 row_mask:0xf bank_mask:0xf
  s_nop 1
  v_mfma_f32_16x16x32_bf16 v[20:23], v[12:15], v[80:83], v[20:23]
  v_and_b32_dpp v16, v24, v32 row_newbcast:14 row_mask:0xf bank_mask:0xf
  v_and_b32_dpp v17, v24, v33 row_newbcast:14 row_mask:0xf bank_mask:0xf
  v_and_b32_dpp v18, v24, v34 row_newbcast:14 row_mask:0xf bank_mask:0xf
  v_and_b32_dpp v19, v24, v35 row_newbcast:14 row_mask:0xf bank_mask:0xf
  buffer_load_dwordx4 v[92:95], v1, s[44:47], s7 offen nt
  s_add_u32 s7, s7, 0x2000
  s_waitcnt vmcnt(2)
  buffer_load_dwordx4 v[96:99], v1, s[44:47], s7 offen nt
  s_add_u32 s7, s7, 0x2000
  v_mfma_f32_16x16x32_bf16 v[20:23], v[16:19], v[84:87], v[20:23]
  v_and_b32_dpp v12, v24, v32 row_newbcast:3 row_mask:0xf bank_mask:0xf
  v_and_b32_dpp v13, v24, v33 row_newbcast:3 row_mask:0xf bank_mask:0xf
  v_and_b32_dpp v14, v24, v34 row_newbcast:3 row_mask:0xf bank_mask:0xf
  v_and_b32_dpp v15, v24, v35 row_newbcast:3 row_mask:0xf bank_mask:0xf
  s_waitcnt vmcnt(2)
  buffer_load_dwordx4 v[100:103], v1, s[44:47], s7 offen nt
  s_add_u32 s7, s7, 0x2000
  v_mfma_f32_16x16x32_bf16 v[20:23], v[12:15], v[88:91], v[20:23]
  v_and_b32_dpp v16, v24, v32 row_newbcast:7 row_mask:0xf bank_mask:0xf
  v_and_b32_dpp v17, v24, v33 row_newbcast:7 row_mask:0xf bank_mask:0xf
  v_and_b32_dpp v18, v24, v34 row_newbcast:7 row_mask:0xf bank_mask:0xf
  v_and_b32_dpp v19, v24, v35 row_newbcast:7 row_mask:0xf bank_mask:0xf
  s_waitcnt vmcnt(2)
  buffer_load_dwordx4 v[104:107], v1, s[44:47], s7 offen nt
  s_add_u32 s7, s7, 0x2000
  v_mfma_f32_16x16x32_bf16 v[20:23], v[16:19], v[92:95], v[20:23]
  v_and_b32_dpp v12, v24, v32 row_newbcast:11 row_mask:0xf bank_mask:0xf
  v_and_b32_dpp v13, v24, v33 row_newbcast:11 row_mask:0xf bank_mask:0xf
  v_and_b32_dpp v14, v24, v34 row_newbcast:11 row_mask:0xf bank_mask:0xf
  v_and_b32_dpp v15, v24, v35 row_newbcast:11 row_mask:0xf bank_mask:0xf
  s_waitcnt vmcnt(1)
  buffer_load_dwordx4 v[108:111], v1, s[44:47], s7 offen nt
  s_add_u32 s7, s7, 0x2000
  v_mfma_f32_16x16x32_bf16 v[20:23], v[12:15], v[96:99], v[20:23]
  v_and_b32_dpp v16, v24, v32 row_newbcast:15 row_mask:0xf bank_mask:0xf
  v_and_b32_dpp v17, v24, v33 row_newbcast:15 row_mask:0xf bank_mask:0xf
  v_and_b32_dpp v18, v24, v34 row_newbcast:15 row_mask:0xf bank_mask:0xf
  v_and_b32_dpp v19, v24, v35 row_newbcast:15 row_mask:0xf bank_mask:0xf
  s_nop 1
  v_mfma_f32_16x16x32_bf16 v[20:23], v[16:19], v[100:103], v[20:23]
  v_and_b32_dpp v12, v25, v32 row_newbcast:0 row_mask:0xf bank_mask:0xf
  v_and_b32_dpp v13, v25, v33 row_newbcast:0 row_mask:0xf bank_mask:0xf
  v_and_b32_dpp v14, v25, v34 row_newbcast:0 row_mask:0xf bank_mask:0xf
  v_and_b32_dpp v15, v25, v35 row_newbcast:0 row_mask:0xf bank_mask:0xf
  buffer_load_dwordx4 v[112:115], v1, s[44:47], s7 offen nt
  s_add_u32 s7, s7, 0x2000
  s_waitcnt vmcnt(2)
  buffer_load_dwordx4 v[116:119], v1, s[44:47], s7 offen nt
  s_add_u32 s7, s7, 0x2000
  v_mfma_f32_16x16x32_bf16 v[20:23], v[12:15], v[104:107], v[20:23]
  v_and_b32_dpp v16, v25, v32 row_newbcast:4 row_mask:0xf bank_mask:0xf
  v_and_b32_dpp v17, v25, v33 row_newbcast:4 row_mask:0xf bank_mask:0xf
  v_and_b32_dpp v18, v25, v34 row_newbcast:4 row_mask:0xf bank_mask:0xf
  v_and_b32_dpp v19, v25, v35 row_newbcast:4 row_mask:0xf bank_mask:0xf
  s_waitcnt vmcnt(2)
  buffer_load_dwordx4 v[120:123], v1, s[44:47], s7 offen nt
  s_add_u32 s7, s7, 0x2000
  v_mfma_f32_16x16x32_bf16 v[20:23], v[16:19], v[108:111], v[20:23]
  v_and_b32_dpp v12, v25, v32 row_newbcast:8 row_mask:0xf bank_mask:0xf
  v_and_b32_dpp v13, v25, v33 row_newbcast:8 row_mask:0xf bank_mask:0xf
  v_and_b32_dpp v14, v25, v34 row_newbcast:8 row_mask:0xf bank_mask:0xf
  v_and_b32_dpp v15, v25, v35 row_newbcast:8 row_mask:0xf bank_mask:0xf
  s_waitcnt vmcnt(2)
  buffer_load_dwordx4 v[124:127], v1, s[44:47], s7 offen nt
  s_add_u32 s7, s7, 0x2000
  v_mfma_f32_16x16x32_bf16 v[20:23], v[12:15], v[112:115], v[20:23]
  v_and_b32_dpp v16, v25, v32 row_newbcast:12 row_mask:0xf bank_mask:0xf
  v_and_b32_dpp v17, v25, v33 row_newbcast:12 row_mask:0xf bank_mask:0xf
  v_and_b32_dpp v18, v25, v34 row_newbcast:12 row_mask:0xf bank_mask:0xf
  v_and_b32_dpp v19, v25, v35 row_newbcast:12 row_mask:0xf bank_mask:0xf
  s_waitcnt vmcnt(1)
  buffer_load_dwordx4 v[128:131], v1, s[44:47], s7 offen nt
  s_add_u32 s7, s7, 0x2000
  v_mfma_f32_16x16x32_bf16 v[20:23], v[16:19], v[116:119], v[20:23]
  v_and_b32_dpp v12, v25, v32 row_newbcast:1 row_mask:0xf bank_mask:0xf
  v_and_b32_dpp v13, v25, v33 row_newbcast:1 row_mask:0xf bank_mask:0xf
  v_and_b32_dpp v14, v25, v34 row_newbcast:1 row_mask:0xf bank_mask:0xf
  v_and_b32_dpp v15, v25, v35 row_newbcast:1 row_mask:0xf bank_mask:0xf
  s_nop 1
  v_mfma_f32_16x16x32_bf16 v[20:23], v[12:15], v[120:123], v[20:23]
  v_and_b32_dpp v16, v25, v32 row_newbcast:5 row_mask:0xf bank_mask:0xf
  v_and_b32_dpp v17, v25, v33 row_newbcast:5 row_mask:0xf bank_mask:0xf
  v_and_b32_dpp v18, v25, v34 row_newbcast:5 row_mask:0xf bank_mask:0xf
  v_and_b32_dpp v19, v25, v35 row_newbcast:5 row_mask:0xf bank_mask:0xf
  buffer_load_dwordx4 v[132:135], v1, s[44:47], s7 offen nt
  s_add_u32 s7, s7, 0x2000
  s_waitcnt vmcnt(2)
  buffer_load_dwordx4 v[136:139], v1, s[44:47], s7 offen nt
  s_add_u32 s7, s7, 0x2000
  v_mfma_f32_16x16x32_bf16 v[20:23], v[16:19], v[124:127], v[20:23]
  v_and_b32_dpp v12, v25, v32 row_newbcast:9 row_mask:0xf bank_mask:0xf
  v_and_b32_dpp v13, v25, v33 row_newbcast:9 row_mask:0xf bank_mask:0xf
  v_and_b32_dpp v14, v25, v34 row_newbcast:9 row_mask:0xf bank_mask:0xf
  v_and_b32_dpp v15, v25, v35 row_newbcast:9 row_mask:0xf bank_mask:0xf
  s_waitcnt vmcnt(2)
  buffer_load_dwordx4 v[140:143], v1, s[44:47], s7 offen nt
  s_add_u32 s7, s7, 0x2000
  v_mfma_f32_16x16x32_bf16 v[20:23], v[12:15], v[128:131], v[20:23]
  v_and_b32_dpp v16, v25, v32 row_newbcast:13 row_mask:0xf bank_mask:0xf
  v_and_b32_dpp v17, v25, v33 row_newbcast:13 row_mask:0xf bank_mask:0xf
  v_and_b32_dpp v18, v25, v34 row_newbcast:13 row_mask:0xf bank_mask:0xf
  v_and_b32_dpp v19, v25, v35 row_newbcast:13 row_mask:0xf bank_mask:0xf
  s_waitcnt vmcnt(2)
  buffer_load_dwordx4 v[144:147], v1, s[44:47], s7 offen nt
  s_add_u32 s7, s7, 0x2000
  v_mfma_f32_16x16x32_bf16 v[20:23], v[16:19], v[132:135], v[20:23]
  v_and_b32_dpp v12, v25, v32 row_newbcast:2 row_mask:0xf bank_mask:0xf
  v_and_b32_dpp v13, v25, v33 row_newbcast:2 row_mask:0xf bank_mask:0xf
  v_and_b32_dpp v14, v25, v34 row_newbcast:2 row_mask:0xf bank_mask:0xf
  v_and_b32_dpp v15, v25, v35 row_newbcast:2 row_mask:0xf bank_mask:0xf
  v_mov_b32 v31, 0
  s_mov_b32 s14, 65536
L_sp_3:
  ds_read_b32 v30, v31 offset:2948
  s_waitcnt lgkmcnt(0)
  v_readfirstlane_b32 s15, v30
  s_nop 0
  s_cmp_lg_u32 s15, 0
  s_cbranch_scc1 L_spd_4
  s_sub_u32 s14, s14, 1
  s_cmp_lg_u32 s14, 0
  s_cbranch_scc1 L_sp_3
L_spd_4:
  ds_read_b64 v[28:29], v31 offset:2952
  s_waitcnt lgkmcnt(0)
  v_sub_f32 v36, s60, v28
  v_mul_f32 v36, 0x3fb8aa3b, v36
  v_exp_f32 v36, v36
  s_nop 0
  v_mul_f32 v36, v36, v29
  s_waitcnt vmcnt(2)
  buffer_load_dwordx4 v[148:151], v1, s[44:47], s7 offen nt
  s_add_u32 s7, s7, 0x2000
  v_mfma_f32_16x16x32_bf16 v[20:23], v[12:15], v[136:139], v[20:23]
  v_and_b32_dpp v16, v25, v32 row_newbcast:6 row_mask:0xf bank_mask:0xf
  v_and_b32_dpp v17, v25, v33 row_newbcast:6 row_mask:0xf bank_mask:0xf
  v_and_b32_dpp v18, v25, v34 row_newbcast:6 row_mask:0xf bank_mask:0xf
  v_and_b32_dpp v19, v25, v35 row_newbcast:6 row_mask:0xf bank_mask:0xf
  s_waitcnt vmcnt(2)
  buffer_load_dwordx4 v[152:155], v1, s[44:47], s7 offen nt
  s_add_u32 s7, s7, 0x2000
  v_mfma_f32_16x16x32_bf16 v[20:23], v[16:19], v[140:143], v[20:23]
  v_and_b32_dpp v12, v25, v32 row_newbcast:10 row_mask:0xf bank_mask:0xf
  v_and_b32_dpp v13, v25, v33 row_newbcast:10 row_mask:0xf bank_mask:0xf
  v_and_b32_dpp v14, v25, v34 row_newbcast:10 row_mask:0xf bank_mask:0xf
  v_and_b32_dpp v15, v25, v35 row_newbcast:10 row_mask:0xf bank_mask:0xf
  s_waitcnt vmcnt(2)
  buffer_load_dwordx4 v[156:159], v1, s[44:47], s7 offen nt
  s_add_u32 s7, s7, 0x2000
  v_mfma_f32_16x16x32_bf16 v[20:23], v[12:15], v[144:147], v[20:23]
  v_and_b32_dpp v16, v25, v32 row_newbcast:14 row_mask:0xf bank_mask:0xf
  v_and_b32_dpp v17, v25, v33 row_newbcast:14 row_mask:0xf bank_mask:0xf
  v_and_b32_dpp v18, v25, v34 row_newbcast:14 row_mask:0xf bank_mask:0xf
  v_and_b32_dpp v19, v25, v35 row_newbcast:14 row_mask:0xf bank_mask:0xf
  s_waitcnt vmcnt(2)
  buffer_load_dwordx4 v[160:163], v1, s[44:47], s7 offen nt
  s_add_u32 s7, s7, 0x2000
  v_mfma_f32_16x16x32_bf16 v[20:23], v[16:19], v[148:151], v[20:23]
  v_and_b32_dpp v12, v25, v32 row_newbcast:3 row_mask:0xf bank_mask:0xf
  v_and_b32_dpp v13, v25, v33 row_newbcast:3 row_mask:0xf bank_mask:0xf
  v_and_b32_dpp v14, v25, v34 row_newbcast:3 row_mask:0xf bank_mask:0xf
  v_and_b32_dpp v15, v25, v35 row_newbcast:3 row_mask:0xf bank_mask:0xf
  s_waitcnt vmcnt(2)
  buffer_load_dwordx4 v[164:167], v1, s[44:47], s7 offen nt
  v_mfma_f32_16x16x32_bf16 v[20:23], v[12:15], v[152:155], v[20:23]
  v_and_b32_dpp v16, v25, v32 row_newbcast:7 row_mask:0xf bank_mask:0xf
  v_and_b32_dpp v17, v25, v33 row_newbcast:7 row_mask:0xf bank_mask:0xf
  v_and_b32_dpp v18, v25, v34 row_newbcast:7 row_mask:0xf bank_mask:0xf
  v_and_b32_dpp v19, v25, v35 row_newbcast:7 row_mask:0xf bank_mask:0xf
  s_cmp_lt_u32 s3, 4
  s_cbranch_scc0 L_wla_5
  s_waitcnt vmcnt(0)
L_wla_5:
  buffer_load_dwordx4 v[40:43], v3, s[52:55], 0 offen offset:0 nt
  buffer_load_dwordx4 v[44:47], v3, s[52:55], 0 offen offset:1280 nt
  buffer_load_dwordx4 v[48:51], v2, s[48:51], 0 offen offset:0 nt
  buffer_load_dwordx4 v[52:55], v2, s[48:51], 0 offen offset:2560 nt
  s_mov_b32 s14, 5120
  buffer_load_dwordx4 v[56:59], v2, s[48:51], s14 offen offset:0 nt
  s_mov_b32 s14, 5120
  buffer_load_dwordx4 v[60:63], v2, s[48:51], s14 offen offset:2560 nt
  s_waitcnt vmcnt(8)
  v_mfma_f32_16x16x32_bf16 v[20:23], v[16:19], v[156:159], v[20:23]
  v_and_b32_dpp v12, v25, v32 row_newbcast:11 row_mask:0xf bank_mask:0xf
  v_and_b32_dpp v13, v25, v33 row_newbcast:11 row_mask:0xf bank_mask:0xf
  v_and_b32_dpp v14, v25, v34 row_newbcast:11 row_mask:0xf bank_mask:0xf
  v_and_b32_dpp v15, v25, v35 row_newbcast:11 row_mask:0xf bank_mask:0xf
  s_waitcnt vmcnt(7)
  s_nop 0
  v_mfma_f32_16x16x32_bf16 v[20:23], v[12:15], v[160:163], v[20:23]
  v_and_b32_dpp v16, v25, v32 row_newbcast:15 row_mask:0xf bank_mask:0xf
  v_and_b32_dpp v17, v25, v33 row_newbcast:15 row_mask:0xf bank_mask:0xf
  v_and_b32_dpp v18, v25, v34 row_newbcast:15 row_mask:0xf bank_mask:0xf
  v_and_b32_dpp v19, v25, v35 row_newbcast:15 row_mask:0xf bank_mask:0xf
  s_waitcnt vmcnt(6)
  s_nop 0
  v_mfma_f32_16x16x32_bf16 v[20:23], v[16:19], v[164:167], v[20:23]
  s_nop 7
  v_mul_f32 v20, v20, v36
  v_mul_f32 v21, v21, v36
  v_mul_f32 v22, v22, v36
  v_mul_f32 v23, v23, v36
  ds_write_b128 v37, v[20:23] offset:3072
  s_waitcnt lgkmcnt(0)
  s_barrier
  buffer_load_dwordx4 v[64:67], v38, s[56:59], s90 offen sc1
  ds_read_b32 v30, v39 offset:2816
  s_mov_b32 s14, 0x01000100
  s_mov_b32 s15, 0x03020302
  s_waitcnt lgkmcnt(0)
  v_perm_b32 v31, v30, v30, s14
  v_perm_b32 v30, v30, v30, s15
  v_and_b32 v12, v31, v32
  v_and_b32 v13, v31, v33
  v_and_b32 v14, v31, v34
  v_and_b32 v15, v31, v35
  v_and_b32 v16, v30, v32
  v_and_b32 v17, v30, v33
  v_and_b32 v18, v30, v34
  v_and_b32 v19, v30, v35
  s_waitcnt vmcnt(5)
  v_mfma_f32_16x16x32_bf16 v[20:23], v[12:15], v[40:43], 0
  v_mfma_f32_16x16x32_bf16 v[20:23], v[16:19], v[44:47], v[20:23]
  s_mov_b32 s14, 4096
L_h1_6:
  s_waitcnt vmcnt(0)
  v_cmp_eq_u32 vcc, s69, v65
  v_cmp_eq_u32_e64 s[66:67], s69, v67
  s_nop 0
  s_and_b64 vcc, vcc, s[66:67]
  s_cmp_eq_u64 vcc, -1
  s_cbranch_scc1 L_h1d_7
  s_not_b64 exec, vcc
  buffer_load_dwordx4 v[64:67], v38, s[56:59], s90 offen sc1
  s_mov_b64 exec, -1
  s_sub_u32 s14, s14, 1
  s_cmp_lg_u32 s14, 0
  s_cbranch_scc1 L_h1_6
L_h1d_7:
  v_add_f32_dpp v24, v64, v64 row_ror:4 row_mask:0xf bank_mask:0xf
  v_add_f32_dpp v26, v66, v66 row_ror:4 row_mask:0xf bank_mask:0xf
  s_nop 0
  v_add_f32_dpp v24, v24, v24 row_ror:8 row_mask:0xf bank_mask:0xf
  v_add_f32_dpp v26, v26, v26 row_ror:8 row_mask:0xf bank_mask:0xf
  s_nop 1
  v_permlane16_swap_b32 v24, v26
  v_add_f32 v24, v24, v26
  v_cvt_pk_bf16_f32 v24, v24, v24
  s_nop 1
  v_and_b32_dpp v12, v24, v32 row_newbcast:0 row_mask:0xf bank_mask:0xf
  v_and_b32_dpp v13, v24, v33 row_newbcast:0 row_mask:0xf bank_mask:0xf
  v_and_b32_dpp v14, v24, v34 row_newbcast:0 row_mask:0xf bank_mask:0xf
  v_and_b32_dpp v15, v24, v35 row_newbcast:0 row_mask:0xf bank_mask:0xf
  s_nop 1
  v_mfma_f32_16x16x32_bf16 v[20:23], v[12:15], v[48:51], v[20:23]
  v_and_b32_dpp v16, v24, v32 row_newbcast:1 row_mask:0xf bank_mask:0xf
  v_and_b32_dpp v17, v24, v33 row_newbcast:1 row_mask:0xf bank_mask:0xf
  v_and_b32_dpp v18, v24, v34 row_newbcast:1 row_mask:0xf bank_mask:0xf
  v_and_b32_dpp v19, v24, v35 row_newbcast:1 row_mask:0xf bank_mask:0xf
  s_nop 1
  v_mfma_f32_16x16x32_bf16 v[20:23], v[16:19], v[52:55], v[20:23]
  v_and_b32_dpp v12, v24, v32 row_newbcast:2 row_mask:0xf bank_mask:0xf
  v_and_b32_dpp v13, v24, v33 row_newbcast:2 row_mask:0xf bank_mask:0xf
  v_and_b32_dpp v14, v24, v34 row_newbcast:2 row_mask:0xf bank_mask:0xf
  v_and_b32_dpp v15, v24, v35 row_newbcast:2 row_mask:0xf bank_mask:0xf
  s_nop 1
  v_mfma_f32_16x16x32_bf16 v[20:23], v[12:15], v[56:59], v[20:23]
  v_and_b32_dpp v16, v24, v32 row_newbcast:3 row_mask:0xf bank_mask:0xf
  v_and_b32_dpp v17, v24, v33 row_newbcast:3 row_mask:0xf bank_mask:0xf
  v_and_b32_dpp v18, v24, v34 row_newbcast:3 row_mask:0xf bank_mask:0xf
  v_and_b32_dpp v19, v24, v35 row_newbcast:3 row_mask:0xf bank_mask:0xf
  s_nop 1
  v_mfma_f32_16x16x32_bf16 v[20:23], v[16:19], v[60:63], v[20:23]
  s_nop 7
  ds_write_b128 v37, v[20:23] offset:7168
  v_mov_b32 v30, 0
  v_mov_b32 v31, 1
  s_mov_b64 exec, 1
  ds_add_u32 v30, v31 offset:2968
  s_mov_b64 exec, -1
  s_waitcnt lgkmcnt(0)
  s_endpgm
L_aux0:
  s_setprio 0
  s_mov_b32 s90, 0x0
  s_mov_b32 s91, 0x100000
  v_mov_b32 v2, 0x1f8000
  v_lshlrev_b32 v9, 2, v0
  s_mov_b32 s42, 0x500
  s_mov_b32 s43, 0x20000
  s_mov_b32 s58, 0x400000
  s_mov_b32 s59, 0x20000
  s_waitcnt lgkmcnt(0)
  s_mov_b32 s40, s16
  s_mov_b32 s41, s17
  s_mov_b32 s56, s38
  s_mov_b32 s57, s39
  buffer_load_dword v4, v9, s[40:43], 0 offen offset:0
  buffer_load_dword v5, v9, s[40:43], 0 offen offset:256
  buffer_load_dword v6, v9, s[40:43], 0 offen offset:512
  buffer_load_dword v7, v9, s[40:43], 0 offen offset:768
  buffer_load_dword v8, v9, s[40:43], 0 offen offset:1024
  buffer_load_dword v3, v2, s[56:59], 0 offen
  s_mov_b32 s44, s22
  s_mov_b32 s45, s23
  s_mov_b32 s46, 0x500000
  s_mov_b32 s47, 0x20000
  v_lshrrev_b32 v38, 4, v0
  v_mul_u32_u24 v39, 20, v38
  s_mul_i32 s7, s5, 80
  v_add_u32 v39, s7, v39
  v_lshlrev_b32 v39, 13, v39
  v_and_b32 v38, 15, v0
  v_lshlrev_b32 v38, 4, v38
  s_lshl_b32 s7, s4, 8
  v_add3_u32 v39, v39, v38, s7
  s_mov_b32 s7, 0
  buffer_load_dwordx4 v[40:43], v39, s[44:47], s7 offen nt
  s_add_u32 s7, s7, 0x2000
  buffer_load_dwordx4 v[44:47], v39, s[44:47], s7 offen nt
  s_add_u32 s7, s7, 0x2000
  buffer_load_dwordx4 v[48:51], v39, s[44:47], s7 offen nt
  s_add_u32 s7, s7, 0x2000
  buffer_load_dwordx4 v[52:55], v39, s[44:47], s7 offen nt
  s_add_u32 s7, s7, 0x2000
  buffer_load_dwordx4 v[56:59], v39, s[44:47], s7 offen nt
  s_add_u32 s7, s7, 0x2000
  buffer_load_dwordx4 v[60:63], v39, s[44:47], s7 offen nt
  s_add_u32 s7, s7, 0x2000
  buffer_load_dwordx4 v[64:67], v39, s[44:47], s7 offen nt
  s_add_u32 s7, s7, 0x2000
  buffer_load_dwordx4 v[68:71], v39, s[44:47], s7 offen nt
  s_add_u32 s7, s7, 0x2000
  buffer_load_dwordx4 v[72:75], v39, s[44:47], s7 offen nt
  s_add_u32 s7, s7, 0x2000
  buffer_load_dwordx4 v[76:79], v39, s[44:47], s7 offen nt
  s_add_u32 s7, s7, 0x2000
  buffer_load_dwordx4 v[80:83], v39, s[44:47], s7 offen nt
  s_add_u32 s7, s7, 0x2000
  buffer_load_dwordx4 v[84:87], v39, s[44:47], s7 offen nt
  s_add_u32 s7, s7, 0x2000
  buffer_load_dwordx4 v[88:91], v39, s[44:47], s7 offen nt
  s_add_u32 s7, s7, 0x2000
  buffer_load_dwordx4 v[92:95], v39, s[44:47], s7 offen nt
  s_add_u32 s7, s7, 0x2000
  buffer_load_dwordx4 v[96:99], v39, s[44:47], s7 offen nt
  s_add_u32 s7, s7, 0x2000
  buffer_load_dwordx4 v[100:103], v39, s[44:47], s7 offen nt
  s_add_u32 s7, s7, 0x2000
  buffer_load_dwordx4 v[104:107], v39, s[44:47], s7 offen nt
  s_add_u32 s7, s7, 0x2000
  buffer_load_dwordx4 v[108:111], v39, s[44:47], s7 offen nt
  s_add_u32 s7, s7, 0x2000
  buffer_load_dwordx4 v[112:115], v39, s[44:47], s7 offen nt
  s_add_u32 s7, s7, 0x2000
  buffer_load_dwordx4 v[116:119], v39, s[44:47], s7 offen nt
  v_mov_b32 v30, 0
  v_lshlrev_b32 v34, 2, v0
  s_mov_b64 exec, 0xffff
  ds_write_b32 v34, v30 offset:2944
  s_mov_b64 exec, -1
  s_waitcnt lgkmcnt(0)
  s_barrier
  s_lshl_b32 s7, s6, 10
  v_lshlrev_b32 v35, 4, v0
  v_add_u32 v35, s7, v35
  s_lshl_b32 s7, s6, 4
  s_add_u32 s7, s7, 0xc0000
  v_mov_b32 v36, 0x40000000
  v_mov_b32 v37, s7
  v_cmp_eq_u32 vcc, 0, v0
  s_nop 1
  v_cndmask_b32 v36, v36, v37, vcc
  s_mul_i32 s7, s6, 640
  s_add_u32 s7, s7, 0x1d0000
  v_lshlrev_b32 v37, 4, v0
  v_add_u32 v37, s7, v37
  v_mov_b32 v38, 0x40000000
  v_cmp_gt_u32 vcc, 40, v0
  s_nop 1
  v_cndmask_b32 v37, v38, v37, vcc
  s_waitcnt vmcnt(20)
  v_readfirstlane_b32 s68, v3
  s_nop 0
  s_mul_i32 s69, s68, 0x41c64e6d
  s_add_u32 s69, s69, 0x3039
  s_getreg_b32 s18, hwreg(HW_REG_XCC_ID)
  s_and_b32 s18, s18, 15
  s_add_u32 s18, s18, 1
  s_lshl_b32 s18, s18, 4
  s_xor_b32 s21, s69, s18
  v_lshlrev_b32 v10, 16, v4
  v_and_b32 v11, 0xffff0000, v4
  v_lshlrev_b32 v12, 16, v5
  v_and_b32 v13, 0xffff0000, v5
  v_lshlrev_b32 v14, 16, v6
  v_and_b32 v15, 0xffff0000, v6
  v_lshlrev_b32 v16, 16, v7
  v_and_b32 v17, 0xffff0000, v7
  v_lshlrev_b32 v18, 16, v8
  v_and_b32 v19, 0xffff0000, v8
  v_add_f32 v20, v10, v11
  v_add_f32 v20, v20, v12
  v_add_f32 v20, v20, v13
  v_add_f32 v20, v20, v14
  v_add_f32 v20, v20, v15
  v_add_f32 v20, v20, v16
  v_add_f32 v20, v20, v17
  v_add_f32 v20, v20, v18
  v_add_f32 v20, v20, v19
  s_nop 1
  v_add_f32_dpp v20, v20, v20 row_ror:8 row_mask:0xf bank_mask:0xf
  s_nop 1
  v_add_f32_dpp v20, v20, v20 row_ror:4 row_mask:0xf bank_mask:0xf
  s_nop 1
  v_add_f32_dpp v20, v20, v20 row_ror:2 row_mask:0xf bank_mask:0xf
  s_nop 1
  v_add_f32_dpp v20, v20, v20 row_ror:1 row_mask:0xf bank_mask:0xf
  s_nop 1
  v_add_f32_dpp v20, v20, v20 row_bcast:15 row_mask:0xa bank_mask:0xf
  s_nop 1
  v_add_f32_dpp v20, v20, v20 row_bcast:31 row_mask:0xc bank_mask:0xf
  s_nop 0
  v_readlane_b32 s14, v20, 63
  v_mov_b32 v21, 0x3acccccd
  s_nop 0
  v_mul_f32 v21, s14, v21
  v_sub_f32 v22, v10, v21
  v_mul_f32 v20, v22, v22
  v_sub_f32 v22, v11, v21
  v_fmac_f32 v20, v22, v22
  v_sub_f32 v22, v12, v21
  v_fmac_f32 v20, v22, v22
  v_sub_f32 v22, v13, v21
  v_fmac_f32 v20, v22, v22
  v_sub_f32 v22, v14, v21
  v_fmac_f32 v20, v22, v22
  v_sub_f32 v22, v15, v21
  v_fmac_f32 v20, v22, v22
  v_sub_f32 v22, v16, v21
  v_fmac_f32 v20, v22, v22
  v_sub_f32 v22, v17, v21
  v_fmac_f32 v20, v22, v22
  v_sub_f32 v22, v18, v21
  v_fmac_f32 v20, v22, v22
  v_sub_f32 v22, v19, v21
  v_fmac_f32 v20, v22, v22
  s_nop 1
  v_add_f32_dpp v20, v20, v20 row_ror:8 row_mask:0xf bank_mask:0xf
  s_nop 1
  v_add_f32_dpp v20, v20, v20 row_ror:4 row_mask:0xf bank_mask:0xf
  s_nop 1
  v_add_f32_dpp v20, v20, v20 row_ror:2 row_mask:0xf bank_mask:0xf
  s_nop 1
  v_add_f32_dpp v20, v20, v20 row_ror:1 row_mask:0xf bank_mask:0xf
  s_nop 1
  v_add_f32_dpp v20, v20, v20 row_bcast:15 row_mask:0xa bank_mask:0xf
  s_nop 1
  v_add_f32_dpp v20, v20, v20 row_bcast:31 row_mask:0xc bank_mask:0xf
  s_nop 0
  v_readlane_b32 s14, v20, 63
  v_mov_b32 v22, 0x3acccccd
  s_nop 0
  v_mul_f32 v22, s14, v22
  v_cvt_pk_bf16_f32 v23, v21, v22
  v_lshlrev_b32 v21, 16, v23
  v_and_b32 v22, 0xffff0000, v23
  v_add_f32 v22, 0x3727c5ac, v22
  v_cvt_pk_bf16_f32 v22, v22, v22
  v_and_b32 v22, 0xffff0000, v22
  v_sqrt_f32 v22, v22
  s_nop 0
  v_cvt_pk_bf16_f32 v22, v22, v22
  v_and_b32 v22, 0xffff0000, v22
  v_rcp_f32 v23, v22
  v_sub_f32 v10, v10, v21
  v_sub_f32 v11, v11, v21
  v_cvt_pk_bf16_f32 v24, v10, v11
  v_lshlrev_b32 v10, 16, v24
  v_and_b32 v11, 0xffff0000, v24
  v_mul_f32 v25, v10, v23
  v_mul_f32 v26, v11, v23
  v_fma_f32 v27, -v25, v22, v10
  v_fma_f32 v28, -v26, v22, v11
  v_fmac_f32 v25, v27, v23
  v_fmac_f32 v26, v28, v23
  v_cvt_pk_bf16_f32 v4, v25, v26
  v_sub_f32 v12, v12, v21
  v_sub_f32 v13, v13, v21
  v_cvt_pk_bf16_f32 v24, v12, v13
  v_lshlrev_b32 v12, 16, v24
  v_and_b32 v13, 0xffff0000, v24
  v_mul_f32 v25, v12, v23
  v_mul_f32 v26, v13, v23
  v_fma_f32 v27, -v25, v22, v12
  v_fma_f32 v28, -v26, v22, v13
  v_fmac_f32 v25, v27, v23
  v_fmac_f32 v26, v28, v23
  v_cvt_pk_bf16_f32 v5, v25, v26
  v_sub_f32 v14, v14, v21
  v_sub_f32 v15, v15, v21
  v_cvt_pk_bf16_f32 v24, v14, v15
  v_lshlrev_b32 v14, 16, v24
  v_and_b32 v15, 0xffff0000, v24
  v_mul_f32 v25, v14, v23
  v_mul_f32 v26, v15, v23
  v_fma_f32 v27, -v25, v22, v14
  v_fma_f32 v28, -v26, v22, v15
  v_fmac_f32 v25, v27, v23
  v_fmac_f32 v26, v28, v23
  v_cvt_pk_bf16_f32 v6, v25, v26
  v_sub_f32 v16, v16, v21
  v_sub_f32 v17, v17, v21
  v_cvt_pk_bf16_f32 v24, v16, v17
  v_lshlrev_b32 v16, 16, v24
  v_and_b32 v17, 0xffff0000, v24
  v_mul_f32 v25, v16, v23
  v_mul_f32 v26, v17, v23
  v_fma_f32 v27, -v25, v22, v16
  v_fma_f32 v28, -v26, v22, v17
  v_fmac_f32 v25, v27, v23
  v_fmac_f32 v26, v28, v23
  v_cvt_pk_bf16_f32 v7, v25, v26
  v_sub_f32 v18, v18, v21
  v_sub_f32 v19, v19, v21
  v_cvt_pk_bf16_f32 v24, v18, v19
  v_lshlrev_b32 v18, 16, v24
  v_and_b32 v19, 0xffff0000, v24
  v_mul_f32 v25, v18, v23
  v_mul_f32 v26, v19, v23
  v_fma_f32 v27, -v25, v22, v18
  v_fma_f32 v28, -v26, v22, v19
  v_fmac_f32 v25, v27, v23
  v_fmac_f32 v26, v28, v23
  v_cvt_pk_bf16_f32 v8, v25, v26
  v_lshlrev_b32 v9, 2, v0
  ds_write2st64_b32 v9, v4, v5 offset0:0 offset1:1
  ds_write2st64_b32 v9, v6, v7 offset0:2 offset1:3
  ds_write_b32 v9, v8 offset:1024
  v_lshrrev_b32 v20, 4, v0
  v_mul_u32_u24 v20, 40, v20
  s_mul_i32 s7, s5, 160
  v_add_u32 v20, s7, v20
  s_waitcnt lgkmcnt(0)
  ds_read_b64 v[10:11], v20 offset:0
  ds_read_b64 v[12:13], v20 offset:8
  ds_read_b64 v[14:15], v20 offset:16
  ds_read_b64 v[16:17], v20 offset:24
  ds_read_b64 v[18:19], v20 offset:32
  v_and_b32 v21, 1, v0
  v_lshlrev_b32 v21, 4, v21
  v_mov_b32 v22, 0xffff
  v_lshlrev_b32 v21, v21, v22
  v_bfe_u32 v22, v0, 1, 2
  v_mov_b32 v4, 1
  v_lshlrev_b32 v22, v22, v4
  v_bfe_i32 v4, v22, 0, 1
  v_bfe_i32 v5, v22, 1, 1
  v_bfe_i32 v6, v22, 2, 1
  v_bfe_i32 v7, v22, 3, 1
  v_and_b32 v4, v4, v21
  v_and_b32 v5, v5, v21
  v_and_b32 v6, v6, v21
  v_and_b32 v7, v7, v21
  s_mov_b32 s8, 0x01000100
  s_mov_b32 s9, 0x03020302
  s_waitcnt lgkmcnt(0)
  v_perm_b32 v21, v10, v10, s8
  v_and_b32 v24, v21, v4
  v_and_b32 v25, v21, v5
  v_and_b32 v26, v21, v6
  v_and_b32 v27, v21, v7
  s_waitcnt vmcnt(19)
  s_nop 0
  v_mfma_f32_16x16x32_bf16 v[120:123], v[24:27], v[40:43], 0
  v_perm_b32 v21, v10, v10, s9
  v_and_b32 v28, v21, v4
  v_and_b32 v29, v21, v5
  v_and_b32 v30, v21, v6
  v_and_b32 v31, v21, v7
  s_waitcnt vmcnt(18)
  s_nop 0
  v_mfma_f32_16x16x32_bf16 v[120:123], v[28:31], v[44:47], v[120:123]
  v_perm_b32 v21, v11, v11, s8
  v_and_b32 v24, v21, v4
  v_and_b32 v25, v21, v5
  v_and_b32 v26, v21, v6
  v_and_b32 v27, v21, v7
  s_waitcnt vmcnt(17)
  s_nop 0
  v_mfma_f32_16x16x32_bf16 v[120:123], v[24:27], v[48:51], v[120:123]
  v_perm_b32 v21, v11, v11, s9
  v_and_b32 v28, v21, v4
  v_and_b32 v29, v21, v5
  v_and_b32 v30, v21, v6
  v_and_b32 v31, v21, v7
  s_waitcnt vmcnt(16)
  s_nop 0
  v_mfma_f32_16x16x32_bf16 v[120:123], v[28:31], v[52:55], v[120:123]
  v_perm_b32 v21, v12, v12, s8
  v_and_b32 v24, v21, v4
  v_and_b32 v25, v21, v5
  v_and_b32 v26, v21, v6
  v_and_b32 v27, v21, v7
  s_waitcnt vmcnt(15)
  s_nop 0
  v_mfma_f32_16x16x32_bf16 v[120:123], v[24:27], v[56:59], v[120:123]
  v_perm_b32 v21, v12, v12, s9
  v_and_b32 v28, v21, v4
  v_and_b32 v29, v21, v5
  v_and_b32 v30, v21, v6
  v_and_b32 v31, v21, v7
  s_waitcnt vmcnt(14)
  s_nop 0
  v_mfma_f32_16x16x32_bf16 v[120:123], v[28:31], v[60:63], v[120:123]
  v_perm_b32 v21, v13, v13, s8
  v_and_b32 v24, v21, v4
  v_and_b32 v25, v21, v5
  v_and_b32 v26, v21, v6
  v_and_b32 v27, v21, v7
  s_waitcnt vmcnt(13)
  s_nop 0
  v_mfma_f32_16x16x32_bf16 v[120:123], v[24:27], v[64:67], v[120:123]
  v_perm_b32 v21, v13, v13, s9
  v_and_b32 v28, v21, v4
  v_and_b32 v29, v21, v5
  v_and_b32 v30, v21, v6
  v_and_b32 v31, v21, v7
  s_waitcnt vmcnt(12)
  s_nop 0
  v_mfma_f32_16x16x32_bf16 v[120:123], v[28:31], v[68:71], v[120:123]
  v_perm_b32 v21, v14, v14, s8
  v_and_b32 v24, v21, v4
  v_and_b32 v25, v21, v5
  v_and_b32 v26, v21, v6
  v_and_b32 v27, v21, v7
  s_waitcnt vmcnt(11)
  s_nop 0
  v_mfma_f32_16x16x32_bf16 v[120:123], v[24:27], v[72:75], v[120:123]
  v_perm_b32 v21, v14, v14, s9
  v_and_b32 v28, v21, v4
  v_and_b32 v29, v21, v5
  v_and_b32 v30, v21, v6
  v_and_b32 v31, v21, v7
  s_waitcnt vmcnt(10)
  s_nop 0
  v_mfma_f32_16x16x32_bf16 v[120:123], v[28:31], v[76:79], v[120:123]
  v_perm_b32 v21, v15, v15, s8
  v_and_b32 v24, v21, v4
  v_and_b32 v25, v21, v5
  v_and_b32 v26, v21, v6
  v_and_b32 v27, v21, v7
  s_waitcnt vmcnt(9)
  s_nop 0
  v_mfma_f32_16x16x32_bf16 v[120:123], v[24:27], v[80:83], v[120:123]
  v_perm_b32 v21, v15, v15, s9
  v_and_b32 v28, v21, v4
  v_and_b32 v29, v21, v5
  v_and_b32 v30, v21, v6
  v_and_b32 v31, v21, v7
  s_waitcnt vmcnt(8)
  s_nop 0
  v_mfma_f32_16x16x32_bf16 v[120:123], v[28:31], v[84:87], v[120:123]
  v_perm_b32 v21, v16, v16, s8
  v_and_b32 v24, v21, v4
  v_and_b32 v25, v21, v5
  v_and_b32 v26, v21, v6
  v_and_b32 v27, v21, v7
  s_waitcnt vmcnt(7)
  s_nop 0
  v_mfma_f32_16x16x32_bf16 v[120:123], v[24:27], v[88:91], v[120:123]
  v_perm_b32 v21, v16, v16, s9
  v_and_b32 v28, v21, v4
  v_and_b32 v29, v21, v5
  v_and_b32 v30, v21, v6
  v_and_b32 v31, v21, v7
  s_waitcnt vmcnt(6)
  s_nop 0
  v_mfma_f32_16x16x32_bf16 v[120:123], v[28:31], v[92:95], v[120:123]
  v_perm_b32 v21, v17, v17, s8
  v_and_b32 v24, v21, v4
  v_and_b32 v25, v21, v5
  v_and_b32 v26, v21, v6
  v_and_b32 v27, v21, v7
  s_waitcnt vmcnt(5)
  s_nop 0
  v_mfma_f32_16x16x32_bf16 v[120:123], v[24:27], v[96:99], v[120:123]
  v_perm_b32 v21, v17, v17, s9
  v_and_b32 v28, v21, v4
  v_and_b32 v29, v21, v5
  v_and_b32 v30, v21, v6
  v_and_b32 v31, v21, v7
  s_waitcnt vmcnt(4)
  s_nop 0
  v_mfma_f32_16x16x32_bf16 v[120:123], v[28:31], v[100:103], v[120:123]
  v_perm_b32 v21, v18, v18, s8
  v_and_b32 v24, v21, v4
  v_and_b32 v25, v21, v5
  v_and_b32 v26, v21, v6
  v_and_b32 v27, v21, v7
  s_waitcnt vmcnt(3)
  s_nop 0
  v_mfma_f32_16x16x32_bf16 v[120:123], v[24:27], v[104:107], v[120:123]
  v_perm_b32 v21, v18, v18, s9
  v_and_b32 v28, v21, v4
  v_and_b32 v29, v21, v5
  v_and_b32 v30, v21, v6
  v_and_b32 v31, v21, v7
  s_waitcnt vmcnt(2)
  s_nop 0
  v_mfma_f32_16x16x32_bf16 v[120:123], v[28:31], v[108:111], v[120:123]
  v_perm_b32 v21, v19, v19, s8
  v_and_b32 v24, v21, v4
  v_and_b32 v25, v21, v5
  v_and_b32 v26, v21, v6
  v_and_b32 v27, v21, v7
  s_waitcnt vmcnt(1)
  s_nop 0
  v_mfma_f32_16x16x32_bf16 v[120:123], v[24:27], v[112:115], v[120:123]
  v_perm_b32 v21, v19, v19, s9
  v_and_b32 v28, v21, v4
  v_and_b32 v29, v21, v5
  v_and_b32 v30, v21, v6
  v_and_b32 v31, v21, v7
  s_waitcnt vmcnt(0)
  s_nop 0
  v_mfma_f32_16x16x32_bf16 v[120:123], v[28:31], v[116:119], v[120:123]
  s_mov_b32 s8, -1
  s_mov_b32 s9, 0
  v_and_b32 v20, 15, v0
  v_lshlrev_b32 v20, 6, v20
  v_bfe_u32 v21, v0, 4, 1
  v_lshlrev_b32 v21, 5, v21
  v_lshrrev_b32 v22, 5, v0
  v_lshlrev_b32 v22, 4, v22
  v_add3_u32 v20, v20, v21, v22
  s_lshl_b32 s7, s6, 10
  v_add_u32 v33, s7, v20
  v_cndmask_b32_e64 v24, v122, v120, s[8:9]
  v_mov_b32 v25, s21
  v_cndmask_b32_e64 v26, v123, v121, s[8:9]
  v_mov_b32 v27, s21
  buffer_store_dwordx4 v[24:27], v33, s[56:59], 0 offen
  s_lshl_b32 s7, s4, 13
  v_lshlrev_b32 v20, 4, v0
  v_add_u32 v20, s7, v20
  v_add_u32 v21, 0x1000, v20
  s_mov_b32 s14, 64
  s_mov_b32 s20, 0
L_pf_8:
  buffer_load_dwordx4 v[40:43], v20, s[56:59], s90 offen offset:0 sc1 nt
  buffer_load_dwordx4 v[44:47], v20, s[56:59], s90 offen offset:1024 sc1 nt
  buffer_load_dwordx4 v[48:51], v20, s[56:59], s90 offen offset:2048 sc1 nt
  buffer_load_dwordx4 v[52:55], v20, s[56:59], s90 offen offset:3072 sc1 nt
  buffer_load_dwordx4 v[56:59], v21, s[56:59], s90 offen offset:0 sc1 nt
  buffer_load_dwordx4 v[60:63], v21, s[56:59], s90 offen offset:1024 sc1 nt
  buffer_load_dwordx4 v[64:67], v21, s[56:59], s90 offen offset:2048 sc1 nt
  buffer_load_dwordx4 v[68:71], v21, s[56:59], s90 offen offset:3072 sc1 nt
  s_waitcnt vmcnt(0)
  v_min3_u32 v22, v41, v43, v45
  v_min3_u32 v22, v22, v47, v49
  v_min3_u32 v22, v22, v51, v53
  v_min3_u32 v22, v22, v55, v57
  v_min3_u32 v22, v22, v59, v61
  v_min3_u32 v22, v22, v63, v65
  v_min3_u32 v22, v22, v67, v69
  v_min_u32 v22, v22, v71
  v_max3_u32 v23, v41, v43, v45
  v_max3_u32 v23, v23, v47, v49
  v_max3_u32 v23, v23, v51, v53
  v_max3_u32 v23, v23, v55, v57
  v_max3_u32 v23, v23, v59, v61
  v_max3_u32 v23, v23, v63, v65
  v_max3_u32 v23, v23, v67, v69
  v_max_u32 v23, v23, v71
  v_cmp_eq_u32 vcc, s21, v22
  v_cmp_eq_u32_e64 s[66:67], s21, v23
  s_nop 1
  s_and_b64 vcc, vcc, s[66:67]
  s_cmp_eq_u64 vcc, -1
  s_cbranch_scc1 L_pfd_9
  s_sub_u32 s14, s14, 1
  s_cmp_lg_u32 s14, 0
  s_cbranch_scc1 L_pf_8
  s_cmp_lg_u32 s20, 0
  s_cbranch_scc1 L_pft_10
  v_mov_b32 v25, s69
  v_mov_b32 v27, s69
  buffer_store_dwordx4 v[24:27], v33, s[56:59], s91 offen sc1
  s_mov_b32 s20, 1
  s_mov_b32 s19, 4096
L_pft_10:
  s_xor_b32 s90, s90, 0x100000
  s_xor_b32 s21, s21, s18
  s_mov_b32 s14, 1
  s_sub_u32 s19, s19, 1
  s_cmp_lg_u32 s19, 0
  s_cbranch_scc1 L_pf_8
L_pfd_9:
  v_add_f32 v40, v40, v44
  v_add_f32 v42, v42, v46
  v_add_f32 v40, v40, v48
  v_add_f32 v42, v42, v50
  v_add_f32 v40, v40, v52
  v_add_f32 v42, v42, v54
  v_add_f32 v40, v40, v56
  v_add_f32 v42, v42, v58
  v_add_f32 v40, v40, v60
  v_add_f32 v42, v42, v62
  v_add_f32 v40, v40, v64
  v_add_f32 v42, v42, v66
  v_add_f32 v40, v40, v68
  v_add_f32 v42, v42, v70
  v_cvt_pk_bf16_f32 v40, v40, v42
  v_lshlrev_b32 v21, 2, v0
  ds_write_b32 v21, v40 offset:2560
  s_xor_b32 s24, s21, 2
  v_mov_b32 v22, 1
  v_mov_b32 v23, 0
  v_mov_b32 v24, s24
  v_mov_b32 v25, s90
  s_mov_b64 exec, 1
  ds_write_b64 v23, v[24:25] offset:2960
  s_waitcnt lgkmcnt(0)
  ds_write_b32 v23, v22 offset:2944
  s_mov_b64 exec, -1
  s_xor_b32 s68, s69, 1
  s_mov_b32 s93, 0x80000
  v_mov_b32 v28, 0
  v_mov_b32 v29, s68
  v_mov_b32 v30, 0
  v_mov_b32 v31, s68
  buffer_store_dwordx4 v[28:31], v36, s[56:59], 0 offen
  s_waitcnt vmcnt(0)
  v_and_b32 v20, 7, v0
  v_lshlrev_b32 v21, 2, v20
  v_lshlrev_b32 v20, 3, v20
  s_mov_b32 s14, 262144
L_ml_11:
  ds_read_b32 v24, v21 offset:2976
  ds_read_b64 v[26:27], v20 offset:3008
  s_waitcnt lgkmcnt(0)
  v_cmp_ne_u32 vcc, 0, v24
  s_nop 1
  s_cmp_eq_u64 vcc, -1
  s_cbranch_scc1 L_mld_12
  s_sub_u32 s14, s14, 1
  s_cmp_lg_u32 s14, 0
  s_cbranch_scc1 L_ml_11
L_mld_12:
  v_mov_b32 v28, v26
  s_nop 1
  v_max_f32_dpp v28, v28, v28 quad_perm:[1,0,3,2] row_mask:0xf bank_mask:0xf
  s_nop 1
  v_max_f32_dpp v28, v28, v28 quad_perm:[2,3,0,1] row_mask:0xf bank_mask:0xf
  s_nop 1
  v_max_f32_dpp v28, v28, v28 row_half_mirror row_mask:0xf bank_mask:0xf
  v_sub_f32 v26, v26, v28
  v_mul_f32 v26, 0x3fb8aa3b, v26
  v_exp_f32 v26, v26
  s_nop 0
  v_mul_f32 v30, v26, v27
  s_nop 1
  v_add_f32_dpp v30, v30, v30 quad_perm:[1,0,3,2] row_mask:0xf bank_mask:0xf
  s_nop 1
  v_add_f32_dpp v30, v30, v30 quad_perm:[2,3,0,1] row_mask:0xf bank_mask:0xf
  s_nop 1
  v_add_f32_dpp v30, v30, v30 row_half_mirror row_mask:0xf bank_mask:0xf
  v_mov_b32 v29, s21
  v_mov_b32 v31, s21
  s_cmp_lg_u32 s90, 0
  s_cbranch_scc1 L_pg_13
  buffer_store_dwordx4 v[28:31], v36, s[56:59], 0 offen
L_pd_14:
  s_lshl_b32 s7, s4, 7
  s_add_u32 s7, s7, 0xc0000
  v_lshlrev_b32 v21, 1, v20
  v_add_u32 v21, s7, v21
  s_mov_b32 s14, 4096
L_pk_15:
  buffer_load_dwordx4 v[24:27], v21, s[56:59], s90 offen sc1
  s_waitcnt vmcnt(0)
  v_cmp_eq_u32 vcc, s21, v25
  v_cmp_eq_u32_e64 s[66:67], s21, v27
  s_nop 1
  s_and_b64 vcc, vcc, s[66:67]
  s_cmp_eq_u64 vcc, -1
  s_cbranch_scc1 L_pkd_16
  s_sub_u32 s14, s14, 1
  s_cmp_lg_u32 s14, 0
  s_cbranch_scc1 L_pk_15
L_pkd_16:
  v_mov_b32 v28, v24
  s_nop 1
  v_max_f32_dpp v28, v28, v28 quad_perm:[1,0,3,2] row_mask:0xf bank_mask:0xf
  s_nop 1
  v_max_f32_dpp v28, v28, v28 quad_perm:[2,3,0,1] row_mask:0xf bank_mask:0xf
  s_nop 1
  v_max_f32_dpp v28, v28, v28 row_half_mirror row_mask:0xf bank_mask:0xf
  v_sub_f32 v24, v24, v28
  v_mul_f32 v24, 0x3fb8aa3b, v24
  v_exp_f32 v24, v24
  s_nop 0
  v_mul_f32 v29, v24, v26
  s_nop 1
  v_add_f32_dpp v29, v29, v29 quad_perm:[1,0,3,2] row_mask:0xf bank_mask:0xf
  s_nop 1
  v_add_f32_dpp v29, v29, v29 quad_perm:[2,3,0,1] row_mask:0xf bank_mask:0xf
  s_nop 1
  v_add_f32_dpp v29, v29, v29 row_half_mirror row_mask:0xf bank_mask:0xf
  v_rcp_f32 v30, v29
  s_nop 0
  v_fma_f32 v31, -v29, v30, 1.0
  v_fma_f32 v29, v31, v30, v30
  v_mov_b32 v22, 1
  v_mov_b32 v23, 0
  s_mov_b64 exec, 1
  ds_write_b64 v23, v[28:29] offset:2952
  ds_write_b32 v23, v22 offset:2948
  s_mov_b64 exec, -1
  v_lshlrev_b32 v20, 3, v0
  v_mov_b32 v41, s24
  v_mov_b32 v43, s24
  v_mov_b32 v65, s69
  v_mov_b32 v67, s69
  v_mov_b32 v23, 0
  s_setprio 3
  s_waitcnt lgkmcnt(0)
  s_barrier
  ds_read_b64 v[44:45], v20 offset:3072
  ds_read_b64 v[46:47], v20 offset:3584
  ds_read_b64 v[48:49], v20 offset:4096
  ds_read_b64 v[50:51], v20 offset:4608
  ds_read_b64 v[52:53], v20 offset:5120
  ds_read_b64 v[54:55], v20 offset:5632
  ds_read_b64 v[56:57], v20 offset:6144
  ds_read_b64 v[58:59], v20 offset:6656
  s_waitcnt lgkmcnt(0)
  v_add_f32 v44, v44, v46
  v_add_f32 v45, v45, v47
  v_add_f32 v48, v48, v50
  v_add_f32 v49, v49, v51
  v_add_f32 v52, v52, v54
  v_add_f32 v53, v53, v55
  v_add_f32 v56, v56, v58
  v_add_f32 v57, v57, v59
  v_add_f32 v44, v44, v48
  v_add_f32 v45, v45, v49
  v_add_f32 v52, v52, v56
  v_add_f32 v53, v53, v57
  v_add_f32 v40, v44, v52
  v_add_f32 v42, v45, v53
  s_cmp_lg_u32 s90, 0
  s_cbranch_scc1 L_pg_17
  buffer_store_dwordx4 v[40:43], v35, s[56:59], 0 offen
L_pd_18:
  s_mov_b32 s14, 262144
L_yw_19:
  ds_read_b32 v24, v23 offset:2968
  ds_read_b64 v[44:45], v20 offset:7168
  ds_read_b64 v[46:47], v20 offset:7680
  ds_read_b64 v[48:49], v20 offset:8192
  ds_read_b64 v[50:51], v20 offset:8704
  ds_read_b64 v[52:53], v20 offset:9216
  ds_read_b64 v[54:55], v20 offset:9728
  ds_read_b64 v[56:57], v20 offset:10240
  ds_read_b64 v[58:59], v20 offset:10752
  s_waitcnt lgkmcnt(8)
  v_readfirstlane_b32 s15, v24
  s_nop 0
  s_cmp_eq_u32 s15, 8
  s_cbranch_scc1 L_ywd_20
  s_waitcnt lgkmcnt(0)
  s_sub_u32 s14, s14, 1
  s_cmp_lg_u32 s14, 0
  s_cbranch_scc1 L_yw_19
L_ywd_20:
  s_waitcnt lgkmcnt(0)
  v_add_f32 v44, v44, v46
  v_add_f32 v45, v45, v47
  v_add_f32 v48, v48, v50
  v_add_f32 v49, v49, v51
  v_add_f32 v52, v52, v54
  v_add_f32 v53, v53, v55
  v_add_f32 v56, v56, v58
  v_add_f32 v57, v57, v59
  v_add_f32 v44, v44, v48
  v_add_f32 v45, v45, v49
  v_add_f32 v52, v52, v56
  v_add_f32 v53, v53, v57
  v_add_f32 v64, v44, v52
  v_add_f32 v66, v45, v53
  buffer_store_dwordx4 v[64:67], v37, s[56:59], 0 offen sc1
  s_endpgm
L_pg_13:
  buffer_store_dwordx4 v[28:31], v36, s[56:59], s91 offen sc1
  s_branch L_pd_14
L_pg_17:
  buffer_store_dwordx4 v[40:43], v35, s[56:59], s91 offen sc1
  s_branch L_pd_18
L_aux1:
  s_setprio 0
  s_mov_b32 s90, 0x0
  s_mov_b32 s91, 0x100000
  v_mov_b32 v2, 0x1f8000
  v_lshlrev_b32 v9, 2, v0
  s_mov_b32 s42, 0x500
  s_mov_b32 s43, 0x20000
  s_mov_b32 s58, 0x400000
  s_mov_b32 s59, 0x20000
  s_waitcnt lgkmcnt(0)
  s_mov_b32 s40, s16
  s_mov_b32 s41, s17
  s_mov_b32 s56, s38
  s_mov_b32 s57, s39
  buffer_load_dword v4, v9, s[40:43], 0 offen offset:0
  buffer_load_dword v5, v9, s[40:43], 0 offen offset:256
  buffer_load_dword v6, v9, s[40:43], 0 offen offset:512
  buffer_load_dword v7, v9, s[40:43], 0 offen offset:768
  buffer_load_dword v8, v9, s[40:43], 0 offen offset:1024
  buffer_load_dword v3, v2, s[56:59], 0 offen
  s_mov_b32 s44, s28
  s_mov_b32 s45, s29
  s_mov_b32 s46, 0x21c000
  s_mov_b32 s47, 0x20000
  s_mov_b32 s48, s30
  s_mov_b32 s49, s31
  s_mov_b32 s50, 0x21c000
  s_mov_b32 s51, 0x20000
  v_lshrrev_b32 v38, 3, v0
  v_mul_u32_u24 v39, 10, v38
  s_mul_i32 s7, s5, 80
  v_add_u32 v39, s7, v39
  v_mul_u32_u24 v39, 3456, v39
  v_and_b32 v38, 7, v0
  v_lshlrev_b32 v38, 4, v38
  s_lshl_b32 s7, s4, 7
  s_cmp_ge_u32 s4, 27
  s_cselect_b32 s7, 0x40000000, s7
  v_add3_u32 v39, v39, v38, s7
  s_barrier
  s_waitcnt vmcnt(0)
  v_readfirstlane_b32 s68, v3
  s_nop 0
  s_mul_i32 s69, s68, 0x41c64e6d
  s_add_u32 s69, s69, 0x3039
  s_getreg_b32 s18, hwreg(HW_REG_XCC_ID)
  s_and_b32 s18, s18, 15
  s_add_u32 s18, s18, 1
  s_lshl_b32 s18, s18, 4
  s_xor_b32 s21, s69, s18
  s_lshl_b32 s7, s6, 10
  s_add_u32 s7, s7, 0x40000
  v_lshlrev_b32 v37, 4, v0
  v_add_u32 v37, s7, v37
  v_lshlrev_b32 v10, 16, v4
  v_and_b32 v11, 0xffff0000, v4
  v_lshlrev_b32 v12, 16, v5
  v_and_b32 v13, 0xffff0000, v5
  v_lshlrev_b32 v14, 16, v6
  v_and_b32 v15, 0xffff0000, v6
  v_lshlrev_b32 v16, 16, v7
  v_and_b32 v17, 0xffff0000, v7
  v_lshlrev_b32 v18, 16, v8
  v_and_b32 v19, 0xffff0000, v8
  v_add_f32 v20, v10, v11
  v_add_f32 v20, v20, v12
  v_add_f32 v20, v20, v13
  v_add_f32 v20, v20, v14
  v_add_f32 v20, v20, v15
  v_add_f32 v20, v20, v16
  v_add_f32 v20, v20, v17
  v_add_f32 v20, v20, v18
  v_add_f32 v20, v20, v19
  s_nop 1
  v_add_f32_dpp v20, v20, v20 row_ror:8 row_mask:0xf bank_mask:0xf
  s_nop 1
  v_add_f32_dpp v20, v20, v20 row_ror:4 row_mask:0xf bank_mask:0xf
  s_nop 1
  v_add_f32_dpp v20, v20, v20 row_ror:2 row_mask:0xf bank_mask:0xf
  s_nop 1
  v_add_f32_dpp v20, v20, v20 row_ror:1 row_mask:0xf bank_mask:0xf
  s_nop 1
  v_add_f32_dpp v20, v20, v20 row_bcast:15 row_mask:0xa bank_mask:0xf
  s_nop 1
  v_add_f32_dpp v20, v20, v20 row_bcast:31 row_mask:0xc bank_mask:0xf
  s_nop 0
  v_readlane_b32 s14, v20, 63
  v_mov_b32 v21, 0x3acccccd
  s_nop 0
  v_mul_f32 v21, s14, v21
  v_sub_f32 v22, v10, v21
  v_mul_f32 v20, v22, v22
  v_sub_f32 v22, v11, v21
  v_fmac_f32 v20, v22, v22
  v_sub_f32 v22, v12, v21
  v_fmac_f32 v20, v22, v22
  v_sub_f32 v22, v13, v21
  v_fmac_f32 v20, v22, v22
  v_sub_f32 v22, v14, v21
  v_fmac_f32 v20, v22, v22
  v_sub_f32 v22, v15, v21
  v_fmac_f32 v20, v22, v22
  v_sub_f32 v22, v16, v21
  v_fmac_f32 v20, v22, v22
  v_sub_f32 v22, v17, v21
  v_fmac_f32 v20, v22, v22
  v_sub_f32 v22, v18, v21
  v_fmac_f32 v20, v22, v22
  v_sub_f32 v22, v19, v21
  v_fmac_f32 v20, v22, v22
  s_nop 1
  v_add_f32_dpp v20, v20, v20 row_ror:8 row_mask:0xf bank_mask:0xf
  s_nop 1
  v_add_f32_dpp v20, v20, v20 row_ror:4 row_mask:0xf bank_mask:0xf
  s_nop 1
  v_add_f32_dpp v20, v20, v20 row_ror:2 row_mask:0xf bank_mask:0xf
  s_nop 1
  v_add_f32_dpp v20, v20, v20 row_ror:1 row_mask:0xf bank_mask:0xf
  s_nop 1
  v_add_f32_dpp v20, v20, v20 row_bcast:15 row_mask:0xa bank_mask:0xf
  s_nop 1
  v_add_f32_dpp v20, v20, v20 row_bcast:31 row_mask:0xc bank_mask:0xf
  s_nop 0
  v_readlane_b32 s14, v20, 63
  v_mov_b32 v22, 0x3acccccd
  s_nop 0
  v_mul_f32 v22, s14, v22
  v_cvt_pk_bf16_f32 v23, v21, v22
  v_lshlrev_b32 v21, 16, v23
  v_and_b32 v22, 0xffff0000, v23
  v_add_f32 v22, 0x3727c5ac, v22
  v_cvt_pk_bf16_f32 v22, v22, v22
  v_and_b32 v22, 0xffff0000, v22
  v_sqrt_f32 v22, v22
  s_nop 0
  v_cvt_pk_bf16_f32 v22, v22, v22
  v_and_b32 v22, 0xffff0000, v22
  v_rcp_f32 v23, v22
  v_sub_f32 v10, v10, v21
  v_sub_f32 v11, v11, v21
  v_cvt_pk_bf16_f32 v24, v10, v11
  v_lshlrev_b32 v10, 16, v24
  v_and_b32 v11, 0xffff0000, v24
  v_mul_f32 v25, v10, v23
  v_mul_f32 v26, v11, v23
  v_fma_f32 v27, -v25, v22, v10
  v_fma_f32 v28, -v26, v22, v11
  v_fmac_f32 v25, v27, v23
  v_fmac_f32 v26, v28, v23
  v_cvt_pk_bf16_f32 v4, v25, v26
  v_sub_f32 v12, v12, v21
  v_sub_f32 v13, v13, v21
  v_cvt_pk_bf16_f32 v24, v12, v13
  v_lshlrev_b32 v12, 16, v24
  v_and_b32 v13, 0xffff0000, v24
  v_mul_f32 v25, v12, v23
  v_mul_f32 v26, v13, v23
  v_fma_f32 v27, -v25, v22, v12
  v_fma_f32 v28, -v26, v22, v13
  v_fmac_f32 v25, v27, v23
  v_fmac_f32 v26, v28, v23
  v_cvt_pk_bf16_f32 v5, v25, v26
  v_sub_f32 v14, v14, v21
  v_sub_f32 v15, v15, v21
  v_cvt_pk_bf16_f32 v24, v14, v15
  v_lshlrev_b32 v14, 16, v24
  v_and_b32 v15, 0xffff0000, v24
  v_mul_f32 v25, v14, v23
  v_mul_f32 v26, v15, v23
  v_fma_f32 v27, -v25, v22, v14
  v_fma_f32 v28, -v26, v22, v15
  v_fmac_f32 v25, v27, v23
  v_fmac_f32 v26, v28, v23
  v_cvt_pk_bf16_f32 v6, v25, v26
  v_sub_f32 v16, v16, v21
  v_sub_f32 v17, v17, v21
  v_cvt_pk_bf16_f32 v24, v16, v17
  v_lshlrev_b32 v16, 16, v24
  v_and_b32 v17, 0xffff0000, v24
  v_mul_f32 v25, v16, v23
  v_mul_f32 v26, v17, v23
  v_fma_f32 v27, -v25, v22, v16
  v_fma_f32 v28, -v26, v22, v17
  v_fmac_f32 v25, v27, v23
  v_fmac_f32 v26, v28, v23
  v_cvt_pk_bf16_f32 v7, v25, v26
  v_sub_f32 v18, v18, v21
  v_sub_f32 v19, v19, v21
  v_cvt_pk_bf16_f32 v24, v18, v19
  v_lshlrev_b32 v18, 16, v24
  v_and_b32 v19, 0xffff0000, v24
  v_mul_f32 v25, v18, v23
  v_mul_f32 v26, v19, v23
  v_fma_f32 v27, -v25, v22, v18
  v_fma_f32 v28, -v26, v22, v19
  v_fmac_f32 v25, v27, v23
  v_fmac_f32 v26, v28, v23
  v_cvt_pk_bf16_f32 v8, v25, v26
  v_lshlrev_b32 v9, 2, v0
  ds_write2st64_b32 v9, v4, v5 offset0:5 offset1:6
  ds_write2st64_b32 v9, v6, v7 offset0:7 offset1:8
  ds_write_b32 v9, v8 offset:2304
  s_mov_b32 s7, 0
  buffer_load_dwordx4 v[40:43], v39, s[44:47], s7 offen nt
  buffer_load_dwordx4 v[44:47], v39, s[48:51], s7 offen nt
  s_add_u32 s7, s7, 3456
  buffer_load_dwordx4 v[48:51], v39, s[44:47], s7 offen nt
  buffer_load_dwordx4 v[52:55], v39, s[48:51], s7 offen nt
  s_add_u32 s7, s7, 3456
  buffer_load_dwordx4 v[56:59], v39, s[44:47], s7 offen nt
  buffer_load_dwordx4 v[60:63], v39, s[48:51], s7 offen nt
  s_add_u32 s7, s7, 3456
  buffer_load_dwordx4 v[64:67], v39, s[44:47], s7 offen nt
  buffer_load_dwordx4 v[68:71], v39, s[48:51], s7 offen nt
  s_add_u32 s7, s7, 3456
  buffer_load_dwordx4 v[72:75], v39, s[44:47], s7 offen nt
  buffer_load_dwordx4 v[76:79], v39, s[48:51], s7 offen nt
  s_add_u32 s7, s7, 3456
  buffer_load_dwordx4 v[80:83], v39, s[44:47], s7 offen nt
  buffer_load_dwordx4 v[84:87], v39, s[48:51], s7 offen nt
  s_add_u32 s7, s7, 3456
  buffer_load_dwordx4 v[88:91], v39, s[44:47], s7 offen nt
  buffer_load_dwordx4 v[92:95], v39, s[48:51], s7 offen nt
  s_add_u32 s7, s7, 3456
  buffer_load_dwordx4 v[96:99], v39, s[44:47], s7 offen nt
  buffer_load_dwordx4 v[100:103], v39, s[48:51], s7 offen nt
  s_add_u32 s7, s7, 3456
  buffer_load_dwordx4 v[104:107], v39, s[44:47], s7 offen nt
  buffer_load_dwordx4 v[108:111], v39, s[48:51], s7 offen nt
  s_add_u32 s7, s7, 3456
  buffer_load_dwordx4 v[112:115], v39, s[44:47], s7 offen nt
  buffer_load_dwordx4 v[116:119], v39, s[48:51], s7 offen nt
  v_lshrrev_b32 v20, 3, v0
  v_mul_u32_u24 v20, 20, v20
  s_mul_i32 s7, s5, 160
  v_add_u32 v20, s7, v20
  v_add_u32 v20, 1280, v20
  s_waitcnt lgkmcnt(0)
  ds_read2_b32 v[10:11], v20 offset0:0 offset1:1
  ds_read2_b32 v[12:13], v20 offset0:2 offset1:3
  ds_read_b32 v14, v20 offset:16
  v_and_b32 v21, 1, v0
  v_lshlrev_b32 v21, 4, v21
  v_mov_b32 v22, 0xffff
  v_lshlrev_b32 v21, v21, v22
  v_bfe_u32 v22, v0, 1, 2
  v_mov_b32 v4, 1
  v_lshlrev_b32 v22, v22, v4
  v_bfe_i32 v4, v22, 0, 1
  v_bfe_i32 v5, v22, 1, 1
  v_bfe_i32 v6, v22, 2, 1
  v_bfe_i32 v7, v22, 3, 1
  v_and_b32 v4, v4, v21
  v_and_b32 v5, v5, v21
  v_and_b32 v6, v6, v21
  v_and_b32 v7, v7, v21
  s_mov_b32 s8, 0x01000100
  s_mov_b32 s9, 0x03020302
  s_waitcnt lgkmcnt(0)
  v_perm_b32 v21, v10, v10, s8
  v_and_b32 v24, v21, v4
  v_and_b32 v25, v21, v5
  v_and_b32 v26, v21, v6
  v_and_b32 v27, v21, v7
  s_waitcnt vmcnt(18)
  s_nop 0
  v_mfma_f32_16x16x32_bf16 v[120:123], v[24:27], v[40:43], 0
  v_mfma_f32_16x16x32_bf16 v[124:127], v[24:27], v[44:47], 0
  v_perm_b32 v21, v10, v10, s9
  v_and_b32 v28, v21, v4
  v_and_b32 v29, v21, v5
  v_and_b32 v30, v21, v6
  v_and_b32 v31, v21, v7
  s_waitcnt vmcnt(16)
  s_nop 0
  v_mfma_f32_16x16x32_bf16 v[120:123], v[28:31], v[48:51], v[120:123]
  v_mfma_f32_16x16x32_bf16 v[124:127], v[28:31], v[52:55], v[124:127]
  v_perm_b32 v21, v11, v11, s8
  v_and_b32 v24, v21, v4
  v_and_b32 v25, v21, v5
  v_and_b32 v26, v21, v6
  v_and_b32 v27, v21, v7
  s_waitcnt vmcnt(14)
  s_nop 0
  v_mfma_f32_16x16x32_bf16 v[120:123], v[24:27], v[56:59], v[120:123]
  v_mfma_f32_16x16x32_bf16 v[124:127], v[24:27], v[60:63], v[124:127]
  v_perm_b32 v21, v11, v11, s9
  v_and_b32 v28, v21, v4
  v_and_b32 v29, v21, v5
  v_and_b32 v30, v21, v6
  v_and_b32 v31, v21, v7
  s_waitcnt vmcnt(12)
  s_nop 0
  v_mfma_f32_16x16x32_bf16 v[120:123], v[28:31], v[64:67], v[120:123]
  v_mfma_f32_16x16x32_bf16 v[124:127], v[28:31], v[68:71], v[124:127]
  v_perm_b32 v21, v12, v12, s8
  v_and_b32 v24, v21, v4
  v_and_b32 v25, v21, v5
  v_and_b32 v26, v21, v6
  v_and_b32 v27, v21, v7
  s_waitcnt vmcnt(10)
  s_nop 0
  v_mfma_f32_16x16x32_bf16 v[120:123], v[24:27], v[72:75], v[120:123]
  v_mfma_f32_16x16x32_bf16 v[124:127], v[24:27], v[76:79], v[124:127]
  v_perm_b32 v21, v12, v12, s9
  v_and_b32 v28, v21, v4
  v_and_b32 v29, v21, v5
  v_and_b32 v30, v21, v6
  v_and_b32 v31, v21, v7
  s_waitcnt vmcnt(8)
  s_nop 0
  v_mfma_f32_16x16x32_bf16 v[120:123], v[28:31], v[80:83], v[120:123]
  v_mfma_f32_16x16x32_bf16 v[124:127], v[28:31], v[84:87], v[124:127]
  v_perm_b32 v21, v13, v13, s8
  v_and_b32 v24, v21, v4
  v_and_b32 v25, v21, v5
  v_and_b32 v26, v21, v6
  v_and_b32 v27, v21, v7
  s_waitcnt vmcnt(6)
  s_nop 0
  v_mfma_f32_16x16x32_bf16 v[120:123], v[24:27], v[88:91], v[120:123]
  v_mfma_f32_16x16x32_bf16 v[124:127], v[24:27], v[92:95], v[124:127]
  v_perm_b32 v21, v13, v13, s9
  v_and_b32 v28, v21, v4
  v_and_b32 v29, v21, v5
  v_and_b32 v30, v21, v6
  v_and_b32 v31, v21, v7
  s_waitcnt vmcnt(4)
  s_nop 0
  v_mfma_f32_16x16x32_bf16 v[120:123], v[28:31], v[96:99], v[120:123]
  v_mfma_f32_16x16x32_bf16 v[124:127], v[28:31], v[100:103], v[124:127]
  v_perm_b32 v21, v14, v14, s8
  v_and_b32 v24, v21, v4
  v_and_b32 v25, v21, v5
  v_and_b32 v26, v21, v6
  v_and_b32 v27, v21, v7
  s_waitcnt vmcnt(2)
  s_nop 0
  v_mfma_f32_16x16x32_bf16 v[120:123], v[24:27], v[104:107], v[120:123]
  v_mfma_f32_16x16x32_bf16 v[124:127], v[24:27], v[108:111], v[124:127]
  v_perm_b32 v21, v14, v14, s9
  v_and_b32 v28, v21, v4
  v_and_b32 v29, v21, v5
  v_and_b32 v30, v21, v6
  v_and_b32 v31, v21, v7
  s_waitcnt vmcnt(0)
  s_nop 0
  v_mfma_f32_16x16x32_bf16 v[120:123], v[28:31], v[112:115], v[120:123]
  v_mfma_f32_16x16x32_bf16 v[124:127], v[28:31], v[116:119], v[124:127]
  v_lshrrev_b32 v20, 5, v0
  v_lshlrev_b32 v20, 8, v20
  v_and_b32 v21, 7, v0
  v_lshlrev_b32 v21, 5, v21
  v_bfe_u32 v22, v0, 4, 1
  v_lshlrev_b32 v22, 4, v22
  v_add3_u32 v20, v20, v21, v22
  s_mov_b32 exec_lo, 0x00ff00ff
  s_mov_b32 exec_hi, 0xff00ff00
  ds_write_b128 v20, v[120:123] offset:11264
  ds_write_b128 v20, v[124:127] offset:11776
  s_mov_b64 exec, -1
  v_lshrrev_b32 v20, 5, v0
  v_lshlrev_b32 v20, 9, v20
  v_and_b32 v21, 31, v0
  v_lshlrev_b32 v21, 3, v21
  v_add_u32 v20, v20, v21
  s_waitcnt lgkmcnt(0)
  ds_read_b64 v[24:25], v20 offset:11264
  ds_read_b64 v[26:27], v20 offset:11520
  s_waitcnt lgkmcnt(0)
  v_add_f32 v28, v24, v26
  v_mov_b32 v29, s21
  v_add_f32 v30, v25, v27
  v_mov_b32 v31, s21
  buffer_store_dwordx4 v[28:31], v37, s[56:59], 0 offen
  s_lshl_b32 s7, s4, 13
  s_add_u32 s7, s7, 0x40000
  v_lshlrev_b32 v20, 4, v0
  v_add_u32 v20, s7, v20
  v_add_u32 v21, 0x1000, v20
  s_mov_b32 s14, 64
  s_mov_b32 s20, 0
L_pf_21:
  buffer_load_dwordx4 v[40:43], v20, s[56:59], s90 offen offset:0 sc1 nt
  buffer_load_dwordx4 v[44:47], v20, s[56:59], s90 offen offset:1024 sc1 nt
  buffer_load_dwordx4 v[48:51], v20, s[56:59], s90 offen offset:2048 sc1 nt
  buffer_load_dwordx4 v[52:55], v20, s[56:59], s90 offen offset:3072 sc1 nt
  buffer_load_dwordx4 v[56:59], v21, s[56:59], s90 offen offset:0 sc1 nt
  buffer_load_dwordx4 v[60:63], v21, s[56:59], s90 offen offset:1024 sc1 nt
  buffer_load_dwordx4 v[64:67], v21, s[56:59], s90 offen offset:2048 sc1 nt
  buffer_load_dwordx4 v[68:71], v21, s[56:59], s90 offen offset:3072 sc1 nt
  s_waitcnt vmcnt(0)
  v_min3_u32 v22, v41, v43, v45
  v_min3_u32 v22, v22, v47, v49
  v_min3_u32 v22, v22, v51, v53
  v_min3_u32 v22, v22, v55, v57
  v_min3_u32 v22, v22, v59, v61
  v_min3_u32 v22, v22, v63, v65
  v_min3_u32 v22, v22, v67, v69
  v_min_u32 v22, v22, v71
  v_max3_u32 v23, v41, v43, v45
  v_max3_u32 v23, v23, v47, v49
  v_max3_u32 v23, v23, v51, v53
  v_max3_u32 v23, v23, v55, v57
  v_max3_u32 v23, v23, v59, v61
  v_max3_u32 v23, v23, v63, v65
  v_max3_u32 v23, v23, v67, v69
  v_max_u32 v23, v23, v71
  v_cmp_eq_u32 vcc, s21, v22
  v_cmp_eq_u32_e64 s[66:67], s21, v23
  s_nop 1
  s_and_b64 vcc, vcc, s[66:67]
  s_cmp_eq_u64 vcc, -1
  s_cbranch_scc1 L_pfd_22
  s_sub_u32 s14, s14, 1
  s_cmp_lg_u32 s14, 0
  s_cbranch_scc1 L_pf_21
  s_cmp_lg_u32 s20, 0
  s_cbranch_scc1 L_pft_23
  v_mov_b32 v29, s69
  v_mov_b32 v31, s69
  buffer_store_dwordx4 v[28:31], v37, s[56:59], s91 offen sc1
  s_mov_b32 s20, 1
  s_mov_b32 s19, 4096
L_pft_23:
  s_xor_b32 s90, s90, 0x100000
  s_xor_b32 s21, s21, s18
  s_mov_b32 s14, 1
  s_sub_u32 s19, s19, 1
  s_cmp_lg_u32 s19, 0
  s_cbranch_scc1 L_pf_21
L_pfd_22:
  v_add_f32 v40, v40, v44
  v_add_f32 v42, v42, v46
  v_add_f32 v40, v40, v48
  v_add_f32 v42, v42, v50
  v_add_f32 v40, v40, v52
  v_add_f32 v42, v42, v54
  v_add_f32 v40, v40, v56
  v_add_f32 v42, v42, v58
  v_add_f32 v40, v40, v60
  v_add_f32 v42, v42, v62
  v_add_f32 v40, v40, v64
  v_add_f32 v42, v42, v66
  v_add_f32 v40, v40, v68
  v_add_f32 v42, v42, v70
  v_cvt_pk_bf16_f32 v40, v40, v42
  v_lshlrev_b32 v44, 16, v40
  v_and_b32 v45, 0xffff0000, v40
  v_mov_b32 v46, v44
  v_mov_b32 v47, v45
  s_nop 0
  v_permlane32_swap_b32 v46, v48
  v_permlane32_swap_b32 v47, v49
  v_mul_f32 v50, 0xbfb8aa3b, v44
  v_exp_f32 v50, v50
  s_nop 0
  v_add_f32 v50, 1.0, v50
  v_rcp_f32 v51, v50
  s_nop 0
  v_mul_f32 v44, v44, v51
  v_mul_f32 v50, 0xbfb8aa3b, v45
  v_exp_f32 v50, v50
  s_nop 0
  v_add_f32 v50, 1.0, v50
  v_rcp_f32 v51, v50
  s_nop 0
  v_mul_f32 v45, v45, v51
  v_cvt_pk_bf16_f32 v50, v44, v45
  v_lshlrev_b32 v44, 16, v50
  v_and_b32 v45, 0xffff0000, v50
  v_mul_f32 v44, v44, v48
  v_mul_f32 v45, v45, v49
  v_cvt_pk_bf16_f32 v50, v44, v45
  v_lshlrev_b32 v21, 2, v0
  s_mov_b32 exec_lo, -1
  s_mov_b32 exec_hi, 0
  ds_write_b32 v21, v50 offset:2816
  s_mov_b64 exec, -1
  s_lshr_b32 s7, s2, 5
  s_lshl_b32 s7, s7, 3
  s_and_b32 s8, s2, 7
  s_add_u32 s7, s7, s8
  s_lshl_b32 s7, s7, 2
  s_bfe_u32 s8, s2, 0x20003
  s_add_u32 s28, s7, s8
  s_lshl_b32 s7, s28, 3
  v_mov_b32 v20, s7
  buffer_load_dwordx2 v[30:31], v20, s[40:43], 0 offen
  s_mov_b32 s60, s34
  s_mov_b32 s61, s35
  s_mov_b32 s62, 0x500
  s_mov_b32 s63, 0x20000
  s_mul_i32 s7, s28, 205
  s_lshr_b32 s7, s7, 12
  s_mul_i32 s8, s7, 20
  s_sub_u32 s8, s28, s8
  s_mul_i32 s7, s7, 640
  s_lshl_b32 s8, s8, 5
  s_add_u32 s7, s7, s8
  s_add_u32 s7, s7, 0x1d0000
  v_and_b32 v36, 31, v0
  v_mul_u32_u24 v36, 5120, v36
  v_lshrrev_b32 v21, 5, v0
  v_lshlrev_b32 v21, 4, v21
  v_add3_u32 v36, v36, v21, s7
  s_waitcnt vmcnt(0)
  v_lshlrev_b32 v32, 16, v30
  v_and_b32 v33, 0xffff0000, v30
  v_lshlrev_b32 v34, 16, v31
  v_and_b32 v35, 0xffff0000, v31
  s_setprio 3
  s_waitcnt vmcnt(0) lgkmcnt(0)
  s_barrier
  s_cmp_ge_u32 s2, 160
  s_cbranch_scc1 L_a1end_24
  v_mov_b32 v23, 0
  s_mov_b32 s14, 262144
L_y2_25:
  ds_read_b32 v24, v23 offset:2968
  s_waitcnt lgkmcnt(0)
  v_readfirstlane_b32 s15, v24
  s_nop 0
  s_cmp_eq_u32 s15, 8
  s_cbranch_scc1 L_y2d_26
  s_sub_u32 s14, s14, 1
  s_cmp_lg_u32 s14, 0
  s_cbranch_scc1 L_y2_25
L_y2d_26:
  buffer_load_dwordx4 v[40:43], v36, s[56:59], 0 offen sc1
  s_mov_b32 s14, 4096
L_h2_27:
  s_waitcnt vmcnt(0)
  v_cmp_eq_u32 vcc, s69, v41
  v_cmp_eq_u32_e64 s[66:67], s69, v43
  v_add_f32_dpp v24, v40, v40 row_ror:8 row_mask:0xf bank_mask:0xf
  v_add_f32_dpp v26, v42, v42 row_ror:8 row_mask:0xf bank_mask:0xf
  s_nop 0
  v_add_f32_dpp v24, v24, v24 row_ror:4 row_mask:0xf bank_mask:0xf
  v_add_f32_dpp v26, v26, v26 row_ror:4 row_mask:0xf bank_mask:0xf
  s_nop 0
  v_add_f32_dpp v24, v24, v24 row_ror:2 row_mask:0xf bank_mask:0xf
  v_add_f32_dpp v26, v26, v26 row_ror:2 row_mask:0xf bank_mask:0xf
  s_nop 0
  v_add_f32_dpp v24, v24, v24 row_ror:1 row_mask:0xf bank_mask:0xf
  v_add_f32_dpp v26, v26, v26 row_ror:1 row_mask:0xf bank_mask:0xf
  s_and_b64 vcc, vcc, s[66:67]
  v_add_f32_dpp v24, v24, v24 row_bcast:15 row_mask:0xa bank_mask:0xf
  v_add_f32_dpp v26, v26, v26 row_bcast:15 row_mask:0xa bank_mask:0xf
  s_cmp_eq_u64 vcc, -1
  s_cbranch_scc1 L_h2d_28
  s_not_b64 exec, vcc
  buffer_load_dwordx4 v[40:43], v36, s[56:59], 0 offen sc1
  s_mov_b64 exec, -1
  s_sub_u32 s14, s14, 1
  s_cmp_lg_u32 s14, 0
  s_cbranch_scc1 L_h2_27
L_h2d_28:
  s_lshl_b32 s7, s28, 3
  v_mov_b32 v20, s7
  v_readlane_b32 s8, v24, 31
  v_readlane_b32 s9, v26, 31
  v_readlane_b32 s10, v24, 63
  v_readlane_b32 s11, v26, 63
  v_add_f32 v32, s8, v32
  v_add_f32 v33, s9, v33
  v_add_f32 v34, s10, v34
  v_add_f32 v35, s11, v35
  v_cvt_pk_bf16_f32 v32, v32, v33
  v_cvt_pk_bf16_f32 v33, v34, v35
  s_mov_b64 exec, 1
  buffer_store_dwordx2 v[32:33], v20, s[60:63], 0 offen
  s_cmp_lg_u32 s2, 0
  s_cbranch_scc1 L_noep_29
  s_mov_b64 exec, 1
  v_mov_b32 v20, 0x1f8000
  v_mov_b32 v21, s69
  buffer_store_dword v21, v20, s[56:59], 0 offen
L_noep_29:
  s_mov_b64 exec, -1
L_a1end_24:
  s_endpgm
L_end:
  s_endpgm
.fill 4096, 4, 0xbf810000
.section .rodata,"a"
.p2align 6
.amdhsa_kernel parallel_sum__gqa_block_cached__glu_gated_swiglu__decode_kernel
  .amdhsa_next_free_vgpr 168
  .amdhsa_next_free_sgpr 102
  .amdhsa_accum_offset 168
  .amdhsa_group_segment_fixed_size 0
  .amdhsa_kernarg_size 96
  .amdhsa_user_sgpr_count 2
  .amdhsa_user_sgpr_kernarg_segment_ptr 1
  .amdhsa_system_sgpr_workgroup_id_x 1
.end_amdhsa_kernel
```
